```python
import torch

def _softmax(x, axis=-1):
    return torch.softmax(x, dim=axis)
def _gelu(x):
    return torch.nn.functional.gelu(x, approximate="tanh")
def _silu(x):
    return torch.nn.functional.silu(x)
def _sigmoid(x):
    return torch.sigmoid(x)
def _layernorm(x, axis=-1, eps=1e-5):
    m = x.mean(dim=axis, keepdim=True)
    v = x.var(dim=axis, keepdim=True, unbiased=False)
    return (x - m) / torch.sqrt(v + eps)
def _scatter_add(tgt, idx, src, axis=0):
    return tgt.clone().index_add_(axis, idx, src)
def _segment_sum(src, seg, n):
    out = torch.zeros((n,) + src.shape[1:], dtype=src.dtype)
    return out.index_add_(0, seg, src)
def _pad(x, pw):
    flat = tuple(v for pair in reversed(pw) for v in pair)
    return torch.nn.functional.pad(x, flat)

kernel_name = 'recurrent_scan__linear_attn_block__dense_activation_gelu__prompt'

def setup_inputs():

    _w = (lambda a: (lambda t: t.to(torch.bfloat16) if t.is_floating_point() else t)(torch.as_tensor(a)))
    def _A_setup():
        B, S, D = 1, 2048, 512
        return {
            "x": _w((lambda *s: torch.randn(*s, dtype=torch.bfloat16) * 0.05)(B, S, D)),
            "wqkv": _w((lambda *s: torch.randn(*s, dtype=torch.bfloat16) * 0.2)(D, 3 * D)),
            "wo": _w((lambda *s: torch.randn(*s, dtype=torch.bfloat16) * 0.2)(D, D)),
        }
    _A_in = _A_setup()

    def _B_setup():
        B, S, D, F = 1, 2048, 512, 1376
        return {
            "x": _w((lambda *s: torch.randn(*s, dtype=torch.bfloat16) * 0.05)(B, S, D)),
            "w1": _w((lambda *s: torch.randn(*s, dtype=torch.bfloat16) * 0.4)(D, F) * (D ** -0.5)),
            "b1": _w((lambda *s: torch.randn(*s, dtype=torch.bfloat16) * 12.8)(F) * 0.01),
            "w2": _w((lambda *s: torch.randn(*s, dtype=torch.bfloat16) * 0.2)(F, D) * (F ** -0.5)),
            "b2": _w((lambda *s: torch.randn(*s, dtype=torch.bfloat16) * 3.2)(D) * 0.01),
        }
    _B_in = _B_setup()

    return {
        "A_x": _A_in["x"],
        "A_wqkv": _A_in["wqkv"],
        "A_wo": _A_in["wo"],
        "B_x": _B_in["x"],
        "B_w1": _B_in["w1"],
        "B_b1": _B_in["b1"],
        "B_w2": _B_in["w2"],
        "B_b2": _B_in["b2"],
    }

def reference(A_x, A_wqkv, A_wo, B_x, B_w1, B_b1, B_w2, B_b2):
    def _A_ref(x, wqkv, wo):
        B, S, D = x.shape
        H = 32; Dh = D // H
        qkv = (lambda x, *d: x.permute(*d))((x @ wqkv).reshape(B, S, 3, H, Dh), 2, 0, 3, 1, 4)
        q, k, v = qkv[0], qkv[1], qkv[2]
        phi = lambda t: torch.where(t > 0, t + 1, torch.exp(t)) + 1e-6
        pq, pk = phi(q), phi(k)
        kv = torch.einsum("bhsd,bhse->bhde", pk, v)
        z = torch.einsum("bhsd->bhd", pk)
        num = torch.einsum("bhqd,bhde->bhqe", pq, kv)
        den = torch.einsum("bhqd,bhd->bhq", pq, z)[..., None] + 1e-6
        o = num / den
        return (lambda x, *d: x.permute(*d))(o, 0, 2, 1, 3).reshape(B, S, D) @ wo

    def _B_ref(x, w1, b1, w2, b2):
        h = torch.einsum("bsd,df->bsf", x, w1) + b1
        h = _gelu(h)
        return torch.einsum("bsf,fd->bsd", h, w2) + b2

    x = A_x
    xn = _layernorm(x, axis=-1)
    s = _A_ref(xn, A_wqkv, A_wo)
    g = _silu(_B_ref(xn, B_w1, B_b1, B_w2, B_b2))
    return x + s * g
```

```asm
; @launch grid=(256,1,1) block=(512,1,1) lds=163840
.amdgcn_target "amdgcn-amd-amdhsa--gfx950"
.text
.globl recurrent_scan__linear_attn_block__dense_activation_gelu__prompt_kernel
.p2align 8
.type recurrent_scan__linear_attn_block__dense_activation_gelu__prompt_kernel,@function
recurrent_scan__linear_attn_block__dense_activation_gelu__prompt_kernel:
  s_cmp_ge_u32 s2, 256
  s_cbranch_scc1 L_end
  s_load_dwordx16 s[36:51], s[0:1], 0
  v_lshrrev_b32 v1, 6, v0
  v_and_b32 v0, 63, v0
  v_lshlrev_b32 v2, 2, v1
  v_add_u32 v2, 0x26800, v2
  v_mov_b32 v3, 0
  ds_write_b32 v2, v3
  s_lshr_b32 s71, s2, 7
  v_readfirstlane_b32 s70, v1
  s_and_b32 s60, s2, 7
  s_bfe_u32 s61, s2, 0x40003
  s_lshl2_add_u32 s64, s71, s61
  s_and_b32 s69, s2, 3
  s_lshl1_add_u32 s60, s60, s71
  s_add_u32 s64, s64, s69
  s_and_b32 s64, s64, 7
  s_and_b32 s59, s70, 3
  s_cmp_lt_u32 s70, 4
  s_cbranch_scc1 L_loader
  s_load_dwordx4 s[52:55], s[0:1], 64
  s_load_dwordx2 s[56:57], s[0:1], 80
  s_lshr_b32 s62, s61, 1
  s_and_b32 s63, s61, 1
  s_getpc_b64 s[32:33]
L_pc:
  s_mov_b32 s34, L_codeend-L_pc
  s_mov_b32 s35, 0x20000
  s_lshr_b32 s68, s2, 3
  s_lshl2_add_u32 s69, s68, s59
  s_lshl_b32 s69, s69, 7
  v_and_b32 v4, 3, v0
  v_lshl_add_u32 v4, v4, 14, s69
  buffer_load_dword v31, v4, s[32:35], 0 offen
  s_branch L_compute
L_loader:
  v_lshrrev_b32 v24, 3, v0
  v_and_b32 v25, 7, v0
  v_lshrrev_b32 v26, 4, v0
  s_and_b32 s68, s59, 1
  s_lshl_b32 s68, s68, 2
  s_lshl4_add_u32 s74, s60, s59
  v_add_u32 v27, s68, v26
  v_xor_b32 v27, v27, v25
  v_lshlrev_b32 v27, 4, v27
  v_lshl_or_b32 v1, v24, 10, v27
  s_lshl_b32 s74, s74, 13
  s_lshl_b32 s78, s59, 10
  s_mov_b32 s6, 0x200000
  s_mov_b32 s7, 0x20000
  s_mov_b32 s68, s64
  s_lshl_b32 s69, s68, 7
  s_add_u32 s69, s69, s74
  s_add_u32 m0, s78, 0
  s_lshl_b32 s68, s68, 6
  s_waitcnt lgkmcnt(0)
  s_mov_b32 s4, s36
  s_mov_b32 s5, s37
  buffer_load_dwordx4 v1, s[4:7], s69 offen lds
  s_add_u32 m0, s78, 4096
  s_add_u32 s69, s69, 32768
  buffer_load_dwordx4 v1, s[4:7], s69 offen lds
  s_add_u32 m0, s78, 8192
  s_add_u32 s69, s69, 32768
  buffer_load_dwordx4 v1, s[4:7], s69 offen lds
  s_add_u32 m0, s78, 12288
  s_add_u32 s69, s69, 32768
  buffer_load_dwordx4 v1, s[4:7], s69 offen lds
  s_load_dwordx4 s[52:55], s[0:1], 64
  s_load_dwordx2 s[56:57], s[0:1], 80
  s_lshr_b32 s62, s61, 1
  s_and_b32 s63, s61, 1
  s_setprio 1
  s_lshl_b32 s69, s62, 7
  s_cmp_eq_u32 s63, 0
  s_mov_b32 s72, 0xac0
  s_cmov_b32 s72, 0xc00
  s_mov_b32 s76, 0x80
  s_cmov_b32 s76, 0x400
  s_mov_b32 s10, 0x158000
  s_cmov_b32 s10, 0x180000
  s_cselect_b32 s8, s38, s44
  s_cselect_b32 s9, s39, s45
  s_mov_b32 s11, 0x20000
  s_cselect_b32 s75, 1024, s69
  s_add_u32 s75, s75, s69
  v_and_b32 v27, 1, v26
  v_lshlrev_b32 v27, 2, v27
  v_xor_b32 v27, v27, v25
  v_lshlrev_b32 v27, 4, v27
  v_mad_u32_u24 v2, v24, s72, v27
  s_lshl_b32 s71, s59, 3
  s_mul_i32 s77, s71, s72
  s_add_u32 s75, s75, s77
  s_lshl_b32 s73, s72, 5
  s_mul_i32 s68, s68, s72
  s_add_u32 s68, s68, s75
  s_add_u32 m0, s78, 16384
  s_add_u32 s69, s68, s76
  buffer_load_dwordx4 v2, s[8:11], s68 offen lds
  s_add_u32 m0, s78, 24576
  s_nop 0
  buffer_load_dwordx4 v2, s[8:11], s69 offen lds
  s_add_u32 s68, s68, s73
  s_add_u32 m0, s78, 20480
  s_add_u32 s69, s68, s76
  buffer_load_dwordx4 v2, s[8:11], s68 offen lds
  s_add_u32 m0, s78, 28672
  s_nop 0
  buffer_load_dwordx4 v2, s[8:11], s69 offen lds
  s_lshl_b32 s79, s62, 1
  s_add_u32 s71, s62, 3
  s_min_u32 s79, s79, s71
  s_add_u32 s79, s79, 32
  s_lshl_b32 s68, s79, 6
  s_lshl_b32 s69, s62, 7
  s_cmp_eq_u32 s63, 0
  s_cselect_b32 s68, s69, s68
  s_add_u32 s77, s77, s68
  v_lshl_or_b32 v4, v24, 10, v27
  s_mov_b32 s68, s64
  s_lshl_b32 s68, s68, 6
  s_mul_i32 s68, s68, s72
  s_add_u32 m0, s78, 98304
  s_add_u32 s68, s68, s77
  buffer_load_dwordx4 v2, s[8:11], s68 offen lds
  s_add_u32 m0, s78, 102400
  s_add_u32 s68, s68, s73
  buffer_load_dwordx4 v2, s[8:11], s68 offen lds
  s_waitcnt lgkmcnt(0)
  s_load_dword s58, s[56:57], 0
  s_mov_b32 s16, s56
  s_mov_b32 s17, s57
  s_mov_b32 s18, 0xa00000
  s_mov_b32 s19, 0x20000
  s_mov_b32 s20, s48
  s_mov_b32 s21, s49
  s_mov_b32 s22, 0x158000
  s_mov_b32 s23, 0x20000
  s_mov_b32 s24, s40
  s_mov_b32 s25, s41
  s_mov_b32 s26, 0x80000
  s_mov_b32 s27, 0x20000
  s_mov_b32 s28, s46
  s_mov_b32 s29, s47
  s_mov_b32 s30, 0xac0
  s_mov_b32 s31, 0x20000
  s_lshr_b32 s71, s2, 6
  s_and_b32 s65, s2, 7
  s_lshl_b32 s65, s65, 2
  s_add_u32 s65, s65, s71
  s_bfe_u32 s66, s2, 0x30003
  s_lshl_b32 s67, s71, 1
  s_add_u32 s67, s67, s66
  s_and_b32 s67, s67, 7
  s_add_u32 s3, s71, s66
  s_mul_i32 s47, s71, 3
  s_and_b32 s71, s66, 1
  s_add_u32 s47, s47, s71
  v_lshrrev_b32 v27, 5, v0
  v_bfe_u32 v28, v0, 2, 2
  v_lshl_add_u32 v27, v27, 3, v28
  v_lshlrev_b32 v6, 7, v27
  v_bfe_u32 v27, v0, 3, 1
  v_lshl_or_b32 v6, v27, 6, v6
  v_bfe_u32 v27, v0, 4, 1
  v_lshl_or_b32 v6, v27, 5, v6
  v_and_b32 v27, 3, v0
  v_lshl_or_b32 v6, v27, 3, v6
  s_and_b32 s68, s59, 1
  s_lshl_b32 s68, s68, 6
  v_xor_b32 v6, s68, v6
  v_add_u32 v7, 0x18000, v6
  s_lshr_b32 s68, s59, 1
  s_lshl_b32 s68, s68, 13
  s_add_u32 s68, s68, 16384
  v_add_u32 v6, s68, v6
  v_and_b32 v27, 15, v0
  v_lshlrev_b32 v28, 2, v26
  v_cmp_eq_u32 vcc, v27, v28
  v_mov_b32 v27, 0x3f803f80
  s_nop 0
  v_cndmask_b32 v12, 0, v27, vcc
  v_cndmask_b32 v13, 0, v27, vcc
  v_cndmask_b32 v14, 0, v27, vcc
  v_cndmask_b32 v15, 0, v27, vcc
  v_lshl_add_u32 v8, v0, 4, s78
  v_add_u32 v9, 0x10000, v8
  v_add_u32 v10, 0x20000, v8
  s_lshl_b32 s36, s59, 13
  s_lshl_b32 s69, s66, 7
  s_add_u32 s36, s36, s69
  s_lshl_b32 s48, s47, 15
  s_add_u32 s48, s48, s36
  s_add_u32 s48, s48, 1048576
  s_add_u32 s49, s36, 1409024
  s_lshl_b32 s38, s61, 1
  s_lshr_b32 s68, s60, 3
  s_add_u32 s38, s38, s68
  s_lshl_b32 s38, s38, 2
  s_add_u32 s38, s38, s59
  s_lshl_b32 s38, s38, 12
  s_add_u32 s38, s38, 0xa0000
  s_lshl_b32 s68, s62, 2
  s_add_u32 s68, s68, s59
  s_lshl_b32 s68, s68, 6
  s_and_b32 s69, s59, 1
  s_add_u32 s69, s69, s79
  s_lshl_b32 s69, s69, 6
  s_cmp_eq_u32 s63, 0
  s_cselect_b32 s68, 0x100000, s68
  s_cselect_b32 s69, 0x100000, s69
  v_mov_b32 v27, s68
  v_mov_b32 v28, s69
  v_cmp_gt_u32 vcc, 32, v0
  v_and_b32 v29, 31, v0
  s_nop 0
  v_cndmask_b32 v27, v28, v27, vcc
  v_lshl_add_u32 v30, v29, 1, v27
  s_lshl_b32 s68, s59, 2
  s_add_u32 s68, s68, 0x26800
  v_mov_b32 v11, s68
  v_and_b32 v24, 3, v0
  v_lshlrev_b32 v24, 2, v24
  v_add_u32 v24, 0x26810, v24
  s_mov_b32 s32, s50
  s_mov_b32 s33, s51
  s_mov_b32 s34, 0x400
  s_mov_b32 s35, 0x20000
  buffer_load_ushort v5, v30, s[28:31], 0 offen
  v_and_b32 v28, 7, v0
  v_lshlrev_b32 v28, 4, v28
  s_lshl_b32 s69, s66, 7
  buffer_load_dwordx4 v[252:255], v28, s[32:35], s69 offen
  s_add_u32 s68, s64, 1
  s_and_b32 s68, s68, 7
  s_lshl_b32 s69, s68, 7
  s_add_u32 s69, s69, s74
  s_add_u32 m0, s78, 32768
  s_lshl_b32 s68, s68, 6
  buffer_load_dwordx4 v1, s[4:7], s69 offen lds
  s_add_u32 m0, s78, 36864
  s_add_u32 s69, s69, 32768
  buffer_load_dwordx4 v1, s[4:7], s69 offen lds
  s_add_u32 m0, s78, 40960
  s_add_u32 s69, s69, 32768
  buffer_load_dwordx4 v1, s[4:7], s69 offen lds
  s_add_u32 m0, s78, 45056
  s_add_u32 s69, s69, 32768
  buffer_load_dwordx4 v1, s[4:7], s69 offen lds
  s_mul_i32 s68, s68, s72
  s_add_u32 s68, s68, s75
  s_add_u32 m0, s78, 49152
  s_add_u32 s69, s68, s76
  buffer_load_dwordx4 v2, s[8:11], s68 offen lds
  s_add_u32 m0, s78, 57344
  s_nop 0
  buffer_load_dwordx4 v2, s[8:11], s69 offen lds
  s_add_u32 s68, s68, s73
  s_add_u32 m0, s78, 53248
  s_add_u32 s69, s68, s76
  buffer_load_dwordx4 v2, s[8:11], s68 offen lds
  s_add_u32 m0, s78, 61440
  s_nop 0
  buffer_load_dwordx4 v2, s[8:11], s69 offen lds
  s_waitcnt lgkmcnt(0)
  s_add_u32 s58, s58, 1
  s_waitcnt vmcnt(10)
  s_barrier
  ds_read_b64_tr_b16 v[32:33], v6 offset:0
  ds_read_b64_tr_b16 v[34:35], v6 offset:512
  ds_read_b64_tr_b16 v[36:37], v6 offset:2048
  ds_read_b64_tr_b16 v[38:39], v6 offset:2560
  ds_read_b64_tr_b16 v[40:41], v6 offset:4096
  ds_read_b64_tr_b16 v[42:43], v6 offset:4608
  ds_read_b64_tr_b16 v[44:45], v6 offset:6144
  ds_read_b64_tr_b16 v[46:47], v6 offset:6656
  s_add_u32 s68, s64, 2
  s_and_b32 s68, s68, 7
  s_lshl_b32 s69, s68, 7
  s_add_u32 s69, s69, s74
  s_add_u32 m0, s78, 65536
  s_lshl_b32 s68, s68, 6
  buffer_load_dwordx4 v1, s[4:7], s69 offen lds
  s_add_u32 m0, s78, 69632
  s_add_u32 s69, s69, 32768
  buffer_load_dwordx4 v1, s[4:7], s69 offen lds
  s_add_u32 m0, s78, 73728
  s_add_u32 s69, s69, 32768
  buffer_load_dwordx4 v1, s[4:7], s69 offen lds
  s_add_u32 m0, s78, 77824
  s_add_u32 s69, s69, 32768
  buffer_load_dwordx4 v1, s[4:7], s69 offen lds
  s_setprio 3
  s_waitcnt lgkmcnt(0)
  ds_read_b64_tr_b16 v[48:49], v7 offset:0
  ds_read_b64_tr_b16 v[50:51], v7 offset:512
  ds_read_b64_tr_b16 v[52:53], v7 offset:2048
  ds_read_b64_tr_b16 v[54:55], v7 offset:2560
  ds_read_b64_tr_b16 v[56:57], v7 offset:4096
  ds_read_b64_tr_b16 v[58:59], v7 offset:4608
  ds_read_b64_tr_b16 v[60:61], v7 offset:6144
  ds_read_b64_tr_b16 v[62:63], v7 offset:6656
  v_mfma_f32_16x16x32_bf16 v[16:19], v[12:15], v[32:35], 0
  v_mfma_f32_16x16x32_bf16 v[16:19], v[12:15], v[36:39], v[16:19]
  v_mfma_f32_16x16x32_bf16 v[16:19], v[12:15], v[40:43], v[16:19]
  v_mfma_f32_16x16x32_bf16 v[16:19], v[12:15], v[44:47], v[16:19]
  s_mul_i32 s68, s68, s72
  s_add_u32 s68, s68, s75
  s_add_u32 m0, s78, 81920
  s_add_u32 s69, s68, s76
  buffer_load_dwordx4 v2, s[8:11], s68 offen lds
  s_add_u32 m0, s78, 90112
  s_nop 0
  buffer_load_dwordx4 v2, s[8:11], s69 offen lds
  s_add_u32 s68, s68, s73
  s_add_u32 m0, s78, 86016
  s_add_u32 s69, s68, s76
  buffer_load_dwordx4 v2, s[8:11], s68 offen lds
  s_add_u32 m0, s78, 94208
  s_nop 0
  buffer_load_dwordx4 v2, s[8:11], s69 offen lds
  s_setprio 3
  s_lshl_b32 s68, s59, 8
  s_add_u32 s68, s68, 0x27000
  v_lshl_add_u32 v27, v0, 2, s68
  s_waitcnt lgkmcnt(0)
  v_mfma_f32_16x16x32_bf16 v[20:23], v[12:15], v[48:51], 0
  v_mfma_f32_16x16x32_bf16 v[20:23], v[12:15], v[52:55], v[20:23]
  v_mfma_f32_16x16x32_bf16 v[20:23], v[12:15], v[56:59], v[20:23]
  v_mfma_f32_16x16x32_bf16 v[20:23], v[12:15], v[60:63], v[20:23]
  s_nop 7
  v_permlane32_swap_b32 v16, v20
  v_add_f32 v16, v16, v20
  ds_write_b32 v27, v16
  s_setprio 1
  s_waitcnt vmcnt(8)
  s_barrier
  s_waitcnt vmcnt(0)
  s_add_u32 s68, s64, 3
  s_and_b32 s68, s68, 7
  s_lshl_b32 s69, s68, 7
  s_add_u32 s69, s69, s74
  s_add_u32 m0, s78, 0
  s_lshl_b32 s68, s68, 6
  buffer_load_dwordx4 v1, s[4:7], s69 offen lds
  s_add_u32 m0, s78, 4096
  s_add_u32 s69, s69, 32768
  buffer_load_dwordx4 v1, s[4:7], s69 offen lds
  s_add_u32 m0, s78, 8192
  s_add_u32 s69, s69, 32768
  buffer_load_dwordx4 v1, s[4:7], s69 offen lds
  s_add_u32 m0, s78, 12288
  s_add_u32 s69, s69, 32768
  buffer_load_dwordx4 v1, s[4:7], s69 offen lds
  s_mul_i32 s68, s68, s72
  s_add_u32 s68, s68, s75
  s_add_u32 m0, s78, 16384
  s_add_u32 s69, s68, s76
  buffer_load_dwordx4 v2, s[8:11], s68 offen lds
  s_add_u32 m0, s78, 24576
  s_nop 0
  buffer_load_dwordx4 v2, s[8:11], s69 offen lds
  s_add_u32 s68, s68, s73
  s_add_u32 m0, s78, 20480
  s_add_u32 s69, s68, s76
  buffer_load_dwordx4 v2, s[8:11], s68 offen lds
  s_add_u32 m0, s78, 28672
  s_nop 0
  buffer_load_dwordx4 v2, s[8:11], s69 offen lds
  s_waitcnt lgkmcnt(0)
  s_waitcnt vmcnt(8)
  s_barrier
  s_waitcnt vmcnt(0)
  s_add_u32 s68, s64, 4
  s_and_b32 s68, s68, 7
  s_lshl_b32 s69, s68, 7
  s_add_u32 s69, s69, s74
  s_add_u32 m0, s78, 32768
  s_lshl_b32 s68, s68, 6
  buffer_load_dwordx4 v1, s[4:7], s69 offen lds
  s_add_u32 m0, s78, 36864
  s_add_u32 s69, s69, 32768
  buffer_load_dwordx4 v1, s[4:7], s69 offen lds
  s_add_u32 m0, s78, 40960
  s_add_u32 s69, s69, 32768
  buffer_load_dwordx4 v1, s[4:7], s69 offen lds
  s_add_u32 m0, s78, 45056
  s_add_u32 s69, s69, 32768
  buffer_load_dwordx4 v1, s[4:7], s69 offen lds
  s_mul_i32 s68, s68, s72
  s_add_u32 s68, s68, s75
  s_add_u32 m0, s78, 49152
  s_add_u32 s69, s68, s76
  buffer_load_dwordx4 v2, s[8:11], s68 offen lds
  s_add_u32 m0, s78, 57344
  s_nop 0
  buffer_load_dwordx4 v2, s[8:11], s69 offen lds
  s_add_u32 s68, s68, s73
  s_add_u32 m0, s78, 53248
  s_add_u32 s69, s68, s76
  buffer_load_dwordx4 v2, s[8:11], s68 offen lds
  s_add_u32 m0, s78, 61440
  s_nop 0
  buffer_load_dwordx4 v2, s[8:11], s69 offen lds
  s_waitcnt vmcnt(8)
  s_barrier
  s_add_u32 s68, s64, 5
  s_and_b32 s68, s68, 7
  s_lshl_b32 s69, s68, 7
  s_add_u32 s69, s69, s74
  s_add_u32 m0, s78, 65536
  s_lshl_b32 s68, s68, 6
  buffer_load_dwordx4 v1, s[4:7], s69 offen lds
  s_add_u32 m0, s78, 69632
  s_add_u32 s69, s69, 32768
  buffer_load_dwordx4 v1, s[4:7], s69 offen lds
  s_add_u32 m0, s78, 73728
  s_add_u32 s69, s69, 32768
  buffer_load_dwordx4 v1, s[4:7], s69 offen lds
  s_add_u32 m0, s78, 77824
  s_add_u32 s69, s69, 32768
  buffer_load_dwordx4 v1, s[4:7], s69 offen lds
  s_mul_i32 s68, s68, s72
  s_add_u32 s68, s68, s75
  s_add_u32 m0, s78, 81920
  s_add_u32 s69, s68, s76
  buffer_load_dwordx4 v2, s[8:11], s68 offen lds
  s_add_u32 m0, s78, 90112
  s_nop 0
  buffer_load_dwordx4 v2, s[8:11], s69 offen lds
  s_add_u32 s68, s68, s73
  s_add_u32 m0, s78, 86016
  s_add_u32 s69, s68, s76
  buffer_load_dwordx4 v2, s[8:11], s68 offen lds
  s_add_u32 m0, s78, 94208
  s_nop 0
  buffer_load_dwordx4 v2, s[8:11], s69 offen lds
  s_waitcnt vmcnt(8)
  s_barrier
  s_add_u32 s68, s64, 6
  s_and_b32 s68, s68, 7
  s_lshl_b32 s69, s68, 7
  s_add_u32 s69, s69, s74
  s_add_u32 m0, s78, 0
  s_lshl_b32 s68, s68, 6
  buffer_load_dwordx4 v1, s[4:7], s69 offen lds
  s_add_u32 m0, s78, 4096
  s_add_u32 s69, s69, 32768
  buffer_load_dwordx4 v1, s[4:7], s69 offen lds
  s_add_u32 m0, s78, 8192
  s_add_u32 s69, s69, 32768
  buffer_load_dwordx4 v1, s[4:7], s69 offen lds
  s_add_u32 m0, s78, 12288
  s_add_u32 s69, s69, 32768
  buffer_load_dwordx4 v1, s[4:7], s69 offen lds
  s_mul_i32 s68, s68, s72
  s_add_u32 s68, s68, s75
  s_add_u32 m0, s78, 16384
  s_add_u32 s69, s68, s76
  buffer_load_dwordx4 v2, s[8:11], s68 offen lds
  s_add_u32 m0, s78, 24576
  s_nop 0
  buffer_load_dwordx4 v2, s[8:11], s69 offen lds
  s_add_u32 s68, s68, s73
  s_add_u32 m0, s78, 20480
  s_add_u32 s69, s68, s76
  buffer_load_dwordx4 v2, s[8:11], s68 offen lds
  s_add_u32 m0, s78, 28672
  s_nop 0
  buffer_load_dwordx4 v2, s[8:11], s69 offen lds
  s_waitcnt vmcnt(8)
  s_barrier
  s_add_u32 s68, s64, 7
  s_and_b32 s68, s68, 7
  s_lshl_b32 s69, s68, 7
  s_add_u32 s69, s69, s74
  s_add_u32 m0, s78, 32768
  s_lshl_b32 s68, s68, 6
  buffer_load_dwordx4 v1, s[4:7], s69 offen lds
  s_add_u32 m0, s78, 36864
  s_add_u32 s69, s69, 32768
  buffer_load_dwordx4 v1, s[4:7], s69 offen lds
  s_add_u32 m0, s78, 40960
  s_add_u32 s69, s69, 32768
  buffer_load_dwordx4 v1, s[4:7], s69 offen lds
  s_add_u32 m0, s78, 45056
  s_add_u32 s69, s69, 32768
  buffer_load_dwordx4 v1, s[4:7], s69 offen lds
  s_mul_i32 s68, s68, s72
  s_add_u32 s68, s68, s75
  s_add_u32 m0, s78, 49152
  s_add_u32 s69, s68, s76
  buffer_load_dwordx4 v2, s[8:11], s68 offen lds
  s_add_u32 m0, s78, 57344
  s_nop 0
  buffer_load_dwordx4 v2, s[8:11], s69 offen lds
  s_add_u32 s68, s68, s73
  s_add_u32 m0, s78, 53248
  s_add_u32 s69, s68, s76
  buffer_load_dwordx4 v2, s[8:11], s68 offen lds
  s_add_u32 m0, s78, 61440
  s_nop 0
  buffer_load_dwordx4 v2, s[8:11], s69 offen lds
  s_waitcnt vmcnt(8)
  s_barrier
  v_lshlrev_b32 v29, 3, v0
  buffer_load_dwordx2 v[32:33], v29, s[16:19], s38 offen offset:0 sc1
  buffer_load_dwordx2 v[34:35], v29, s[16:19], s38 offen offset:512 sc1
  buffer_load_dwordx2 v[36:37], v29, s[16:19], s38 offen offset:1024 sc1
  buffer_load_dwordx2 v[38:39], v29, s[16:19], s38 offen offset:1536 sc1
  buffer_load_dwordx2 v[40:41], v29, s[16:19], s38 offen offset:2048 sc1
  buffer_load_dwordx2 v[42:43], v29, s[16:19], s38 offen offset:2560 sc1
  buffer_load_dwordx2 v[44:45], v29, s[16:19], s38 offen offset:3072 sc1
  buffer_load_dwordx2 v[46:47], v29, s[16:19], s38 offen offset:3584 sc1
  s_lshl2_add_u32 s68, s2, s59
  s_mul_i32 s69, s68, 1408
  s_lshl_b32 s68, s68, 9
  v_min_u32 v27, 10, v0
  v_lshlrev_b32 v27, 7, v27
  v_and_b32 v28, 0x180, v27
  buffer_load_dword v20, v27, s[20:23], s69 offen
  buffer_load_dword v21, v28, s[24:27], s68 offen
  s_lshl2_add_u32 s68, s60, s59
  s_lshl_b32 s68, s68, 7
  s_lshl_b32 s69, s60, 7
  s_add_u32 s69, s69, 16384
  v_and_b32 v27, 3, v0
  v_lshl_add_u32 v28, v27, 13, s68
  v_mov_b32 v22, s69
  v_cmp_eq_u32 vcc, 2, v27
  s_nop 1
  v_cndmask_b32 v28, v28, v22, vcc
  s_mov_b32 s68, 0x8000
  buffer_load_dword v22, v28, s[16:19], s68 offen sc1
  s_cmp_ge_u32 s62, 3
  s_cselect_b32 s68, s63, 0
  s_lshl_b32 s68, s68, 6
  s_not_b32 s68, s68
  v_lshrrev_b32 v27, 3, v0
  v_mul_u32_u24 v27, s72, v27
  v_sub_u32 v28, v2, v27
  v_and_b32 v28, s68, v28
  v_add_u32 v23, v27, v28
  s_add_u32 s68, s64, 1
  s_and_b32 s68, s68, 7
  s_lshl_b32 s68, s68, 6
  s_mul_i32 s68, s68, s72
  s_add_u32 s68, s68, s77
  s_add_u32 s69, s68, s73
  buffer_load_dwordx4 v[48:51], v23, s[8:11], s68 offen
  buffer_load_dwordx4 v[52:55], v23, s[8:11], s69 offen
  s_add_u32 s68, s64, 2
  s_and_b32 s68, s68, 7
  s_lshl_b32 s68, s68, 6
  s_mul_i32 s68, s68, s72
  s_add_u32 s68, s68, s77
  s_add_u32 s69, s68, s73
  buffer_load_dwordx4 v[56:59], v23, s[8:11], s68 offen
  buffer_load_dwordx4 v[60:63], v23, s[8:11], s69 offen
  s_waitcnt vmcnt(15)
  s_barrier
  s_setprio 1
  s_waitcnt vmcnt(7)
  v_xor_b32 v228, s58, v33
  v_xor_b32 v229, s58, v35
  v_xor_b32 v230, s58, v37
  v_xor_b32 v231, s58, v39
  v_xor_b32 v232, s58, v41
  v_xor_b32 v233, s58, v43
  v_xor_b32 v234, s58, v45
  v_xor_b32 v235, s58, v47
  v_or3_b32 v228, v228, v229, v230
  v_or3_b32 v231, v231, v232, v233
  v_or3_b32 v228, v228, v234, v235
  v_or_b32 v228, v228, v231
  v_cmp_ne_u32 vcc, 0, v228
  s_nop 1
  s_cbranch_vccz L_cs_x
  s_mov_b32 s71, 65536
L_cs:
  buffer_load_dwordx2 v[32:33], v29, s[16:19], s38 offen offset:0 sc1
  buffer_load_dwordx2 v[34:35], v29, s[16:19], s38 offen offset:512 sc1
  buffer_load_dwordx2 v[36:37], v29, s[16:19], s38 offen offset:1024 sc1
  buffer_load_dwordx2 v[38:39], v29, s[16:19], s38 offen offset:1536 sc1
  buffer_load_dwordx2 v[40:41], v29, s[16:19], s38 offen offset:2048 sc1
  buffer_load_dwordx2 v[42:43], v29, s[16:19], s38 offen offset:2560 sc1
  buffer_load_dwordx2 v[44:45], v29, s[16:19], s38 offen offset:3072 sc1
  buffer_load_dwordx2 v[46:47], v29, s[16:19], s38 offen offset:3584 sc1
  s_waitcnt vmcnt(0)
  v_xor_b32 v228, s58, v33
  v_xor_b32 v229, s58, v35
  v_xor_b32 v230, s58, v37
  v_xor_b32 v231, s58, v39
  v_xor_b32 v232, s58, v41
  v_xor_b32 v233, s58, v43
  v_xor_b32 v234, s58, v45
  v_xor_b32 v235, s58, v47
  v_or3_b32 v228, v228, v229, v230
  v_or3_b32 v231, v231, v232, v233
  v_or3_b32 v228, v228, v234, v235
  v_or_b32 v228, v228, v231
  v_cmp_ne_u32 vcc, 0, v228
  s_sub_u32 s71, s71, 1
  s_cbranch_scc1 L_cs_x
  s_cbranch_vccz L_cs_x
  s_sleep 2
  s_branch L_cs
L_cs_x:
  v_add_f32 v32, v32, v34
  v_add_f32 v36, v36, v38
  v_add_f32 v40, v40, v42
  v_add_f32 v44, v44, v46
  v_add_f32 v32, v32, v36
  v_add_f32 v40, v40, v44
  v_add_f32 v32, v32, v40
  v_cvt_pk_bf16_f32 v33, v32, v32
  v_lshlrev_b32 v33, 16, v33
  v_sub_f32 v32, v32, v33
  v_cvt_pk_bf16_f32 v32, v33, v32
  v_cmp_gt_u32 vcc, 32, v0
  s_lshl_b32 s68, s59, 9
  s_add_u32 s68, s68, 0x26000
  v_add_u32 v29, s68, v29
  v_cndmask_b32 v34, 0, v32, vcc
  v_cndmask_b32 v35, 0, v5, vcc
  v_cndmask_b32 v36, v32, 0, vcc
  v_cndmask_b32 v37, v5, 0, vcc
  ds_write_b64 v29, v[34:35]
  ds_write_b64 v29, v[36:37] offset:3072
  s_setprio 1
  s_add_u32 s68, s64, 3
  s_and_b32 s68, s68, 7
  s_lshl_b32 s68, s68, 6
  s_mul_i32 s68, s68, s72
  s_add_u32 s68, s68, s77
  s_add_u32 s69, s68, s73
  buffer_load_dwordx4 v[64:67], v23, s[8:11], s68 offen
  buffer_load_dwordx4 v[68:71], v23, s[8:11], s69 offen
  s_waitcnt lgkmcnt(0)
  s_barrier
  s_add_u32 s68, s64, 4
  s_and_b32 s68, s68, 7
  s_lshl_b32 s68, s68, 6
  s_mul_i32 s68, s68, s72
  s_add_u32 s68, s68, s77
  s_add_u32 s69, s68, s73
  buffer_load_dwordx4 v[72:75], v23, s[8:11], s68 offen
  buffer_load_dwordx4 v[76:79], v23, s[8:11], s69 offen
  s_add_u32 s68, s64, 5
  s_and_b32 s68, s68, 7
  s_lshl_b32 s68, s68, 6
  s_mul_i32 s68, s68, s72
  s_add_u32 s68, s68, s77
  s_add_u32 s69, s68, s73
  buffer_load_dwordx4 v[80:83], v23, s[8:11], s68 offen
  buffer_load_dwordx4 v[84:87], v23, s[8:11], s69 offen
  s_add_u32 s68, s64, 6
  s_and_b32 s68, s68, 7
  s_lshl_b32 s68, s68, 6
  s_mul_i32 s68, s68, s72
  s_add_u32 s68, s68, s77
  s_add_u32 s69, s68, s73
  buffer_load_dwordx4 v[88:91], v23, s[8:11], s68 offen
  buffer_load_dwordx4 v[92:95], v23, s[8:11], s69 offen
  s_add_u32 s68, s64, 7
  s_and_b32 s68, s68, 7
  s_lshl_b32 s68, s68, 6
  s_mul_i32 s68, s68, s72
  s_add_u32 s68, s68, s77
  s_add_u32 s69, s68, s73
  buffer_load_dwordx4 v[96:99], v23, s[8:11], s68 offen
  buffer_load_dwordx4 v[100:103], v23, s[8:11], s69 offen
  s_mov_b32 s12, s52
  s_mov_b32 s13, s53
  s_mov_b32 s14, 0x200000
  s_mov_b32 s15, 0x20000
  v_and_b32 v28, 7, v0
  v_lshlrev_b32 v28, 4, v28
  v_lshrrev_b32 v29, 3, v0
  v_lshl_or_b32 v19, v29, 10, v28
  s_lshl_b32 s45, s65, 2
  s_add_u32 s45, s45, s59
  s_lshl_b32 s45, s45, 14
  s_lshl_b32 s69, s66, 7
  s_add_u32 s45, s45, s69
  s_add_u32 s70, s45, 8192
  buffer_load_dwordx4 v[244:247], v19, s[4:7], s45 offen
  buffer_load_dwordx4 v[248:251], v19, s[4:7], s70 offen
  s_cmp_eq_u32 s63, 0
  s_cbranch_scc1 L_lA
  v_add_u32 v22, 16, v11
  v_lshlrev_b32 v23, 4, v0
  s_lshl_b32 s68, s60, 2
  s_add_u32 s68, s68, s59
  s_mul_i32 s4, s68, 120832
  s_add_u32 s4, s4, 0x140000
  s_lshl_b32 s5, s79, 11
  s_add_u32 s5, s5, s4
  s_lshl_b32 s69, s62, 13
  s_add_u32 s4, s4, s69
  s_lshl_b32 s6, s68, 5
  s_add_u32 s6, s6, s62
  s_lshl_b32 s6, s6, 2
  s_add_u32 s6, s6, 0x8000
  s_add_u32 s37, s67, 1
  s_and_b32 s37, s37, 7
  s_lshl_b32 s37, s37, 17
  s_add_u32 s37, s37, s36
  s_add_u32 s68, s37, 65536
  buffer_load_dwordx4 v[104:107], v4, s[20:23], s68 offen
  s_add_u32 s68, s37, 98304
  buffer_load_dwordx4 v[108:111], v4, s[20:23], s68 offen
  s_add_u32 s37, s67, 2
  s_and_b32 s37, s37, 7
  s_lshl_b32 s37, s37, 17
  s_add_u32 s37, s37, s36
  s_add_u32 s68, s37, 65536
  buffer_load_dwordx4 v[112:115], v4, s[20:23], s68 offen
  s_add_u32 s68, s37, 98304
  buffer_load_dwordx4 v[116:119], v4, s[20:23], s68 offen
  s_waitcnt vmcnt(18)
  ds_write_b128 v9, v[48:51] offset:40960
  ds_write_b128 v9, v[52:55] offset:45056
  s_waitcnt vmcnt(16)
  ds_write_b128 v9, v[56:59] offset:49152
  ds_write_b128 v9, v[60:63] offset:53248
  s_waitcnt vmcnt(14)
  ds_write_b128 v9, v[64:67] offset:57344
  ds_write_b128 v9, v[68:71] offset:61440
  s_waitcnt vmcnt(12)
  ds_write_b128 v10, v[72:75] offset:0
  ds_write_b128 v10, v[76:79] offset:4096
  ds_read_b32 v28, v24
  s_waitcnt lgkmcnt(0)
  v_cmp_gt_u32 vcc, 1, v28
  s_nop 1
  s_cbranch_vccz L_w1_x
  s_mov_b32 s71, 1048576
L_w1:
  ds_read_b32 v28, v24
  s_sub_u32 s71, s71, 1
  s_waitcnt lgkmcnt(0)
  v_cmp_gt_u32 vcc, 1, v28
  s_cbranch_scc1 L_w1_x
  s_nop 0
  s_cbranch_vccnz L_w1
L_w1_x:
  ds_read_b32 v28, v24 offset:32
  s_waitcnt lgkmcnt(0)
  v_cmp_ne_u32 vcc, 0, v28
  s_nop 1
  s_or_b32 s46, vcc_lo, vcc_hi
  ds_read_b128 v[32:35], v8 offset:53248
  ds_read_b128 v[36:39], v8 offset:57344
  s_waitcnt lgkmcnt(1)
  buffer_store_dwordx4 v[32:35], v23, s[16:19], s4 offen offset:0 sc1
  s_waitcnt lgkmcnt(0)
  buffer_store_dwordx4 v[36:39], v23, s[16:19], s4 offen offset:1024 sc1
  s_waitcnt vmcnt(12)
  ds_write_b128 v10, v[80:83] offset:8192
  ds_write_b128 v10, v[84:87] offset:12288
  s_waitcnt vmcnt(10)
  ds_write_b128 v10, v[88:91] offset:16384
  ds_write_b128 v10, v[92:95] offset:20480
  s_waitcnt vmcnt(8)
  ds_write_b128 v9, v[96:99] offset:24576
  ds_write_b128 v9, v[100:103] offset:28672
  s_waitcnt lgkmcnt(0)
  v_mov_b32 v26, 1
  s_mov_b64 exec, 1
  ds_write_b32 v11, v26
  s_mov_b64 exec, -1
  s_add_u32 s37, s67, 3
  s_and_b32 s37, s37, 7
  s_lshl_b32 s37, s37, 17
  s_add_u32 s37, s37, s36
  s_add_u32 s68, s37, 65536
  buffer_load_dwordx4 v[120:123], v4, s[20:23], s68 offen
  s_add_u32 s68, s37, 98304
  buffer_load_dwordx4 v[124:127], v4, s[20:23], s68 offen
  ds_read_b32 v28, v22
  s_waitcnt lgkmcnt(0)
  v_cmp_gt_u32 vcc, 2, v28
  s_nop 1
  s_cbranch_vccz L_w2_x
  s_mov_b32 s71, 1048576
L_w2:
  ds_read_b32 v28, v22
  s_sub_u32 s71, s71, 1
  s_waitcnt lgkmcnt(0)
  v_cmp_gt_u32 vcc, 2, v28
  s_cbranch_scc1 L_w2_x
  s_nop 0
  s_cbranch_vccnz L_w2
L_w2_x:
  ds_read_b128 v[40:43], v8 offset:61440
  ds_read_b128 v[44:47], v9 offset:0
  s_waitcnt lgkmcnt(1)
  buffer_store_dwordx4 v[40:43], v23, s[16:19], s4 offen offset:2048 sc1
  s_waitcnt lgkmcnt(0)
  buffer_store_dwordx4 v[44:47], v23, s[16:19], s4 offen offset:3072 sc1
  s_add_u32 s37, s67, 4
  s_and_b32 s37, s37, 7
  s_lshl_b32 s37, s37, 17
  s_add_u32 s37, s37, s36
  s_add_u32 s68, s37, 65536
  buffer_load_dwordx4 v[128:131], v4, s[20:23], s68 offen
  s_add_u32 s68, s37, 98304
  buffer_load_dwordx4 v[132:135], v4, s[20:23], s68 offen
  ds_read_b32 v28, v22
  s_waitcnt lgkmcnt(0)
  v_cmp_gt_u32 vcc, 3, v28
  s_nop 1
  s_cbranch_vccz L_w3_x
  s_mov_b32 s71, 1048576
L_w3:
  ds_read_b32 v28, v22
  s_sub_u32 s71, s71, 1
  s_waitcnt lgkmcnt(0)
  v_cmp_gt_u32 vcc, 3, v28
  s_cbranch_scc1 L_w3_x
  s_nop 0
  s_cbranch_vccnz L_w3
L_w3_x:
  ds_read_b128 v[32:35], v9 offset:4096
  ds_read_b128 v[36:39], v9 offset:8192
  s_add_u32 s4, s4, 4096
  s_waitcnt lgkmcnt(1)
  buffer_store_dwordx4 v[32:35], v23, s[16:19], s4 offen offset:0 sc1
  s_waitcnt lgkmcnt(0)
  buffer_store_dwordx4 v[36:39], v23, s[16:19], s4 offen offset:1024 sc1
  s_add_u32 s37, s67, 5
  s_and_b32 s37, s37, 7
  s_lshl_b32 s37, s37, 17
  s_add_u32 s37, s37, s36
  s_add_u32 s68, s37, 65536
  buffer_load_dwordx4 v[136:139], v4, s[20:23], s68 offen
  s_add_u32 s68, s37, 98304
  buffer_load_dwordx4 v[140:143], v4, s[20:23], s68 offen
  ds_read_b32 v28, v22
  s_waitcnt lgkmcnt(0)
  v_cmp_gt_u32 vcc, 4, v28
  s_nop 1
  s_cbranch_vccz L_w4_x
  s_mov_b32 s71, 1048576
L_w4:
  ds_read_b32 v28, v22
  s_sub_u32 s71, s71, 1
  s_waitcnt lgkmcnt(0)
  v_cmp_gt_u32 vcc, 4, v28
  s_cbranch_scc1 L_w4_x
  s_nop 0
  s_cbranch_vccnz L_w4
L_w4_x:
  ds_read_b128 v[40:43], v9 offset:12288
  ds_read_b128 v[44:47], v9 offset:16384
  s_waitcnt lgkmcnt(1)
  buffer_store_dwordx4 v[40:43], v23, s[16:19], s4 offen offset:2048 sc1
  s_waitcnt lgkmcnt(0)
  buffer_store_dwordx4 v[44:47], v23, s[16:19], s4 offen offset:3072 sc1
  v_mov_b32 v26, 2
  s_mov_b64 exec, 1
  ds_write_b32 v11, v26
  s_mov_b64 exec, -1
  s_waitcnt vmcnt(8)
  v_mov_b32 v26, s58
  v_mov_b32 v27, 0
  s_mov_b64 exec, 1
  s_cmp_lg_u32 s46, 0
  s_cbranch_scc1 L_r1
  buffer_store_dword v26, v27, s[16:19], s6 offen
L_r1_x:
  s_mov_b64 exec, -1
  s_add_u32 s6, s6, 24576
  s_add_u32 m0, s78, 0
  s_add_u32 s37, s67, 0
  s_and_b32 s37, s37, 7
  s_lshl_b32 s37, s37, 17
  s_add_u32 s37, s37, s36
  s_add_u32 s68, s37, 0
  buffer_load_dwordx4 v4, s[20:23], s68 offen lds
  s_add_u32 m0, s78, 4096
  s_add_u32 s68, s37, 32768
  buffer_load_dwordx4 v4, s[20:23], s68 offen lds
  s_add_u32 m0, s78, 8192
  s_add_u32 s37, s67, 1
  s_and_b32 s37, s37, 7
  s_lshl_b32 s37, s37, 17
  s_add_u32 s37, s37, s36
  s_add_u32 s68, s37, 0
  buffer_load_dwordx4 v4, s[20:23], s68 offen lds
  s_add_u32 m0, s78, 12288
  s_add_u32 s68, s37, 32768
  buffer_load_dwordx4 v4, s[20:23], s68 offen lds
  s_add_u32 m0, s78, 16384
  s_add_u32 s37, s67, 2
  s_and_b32 s37, s37, 7
  s_lshl_b32 s37, s37, 17
  s_add_u32 s37, s37, s36
  s_add_u32 s68, s37, 0
  buffer_load_dwordx4 v4, s[20:23], s68 offen lds
  s_add_u32 m0, s78, 20480
  s_add_u32 s68, s37, 32768
  buffer_load_dwordx4 v4, s[20:23], s68 offen lds
  s_add_u32 m0, s78, 24576
  s_add_u32 s37, s67, 3
  s_and_b32 s37, s37, 7
  s_lshl_b32 s37, s37, 17
  s_add_u32 s37, s37, s36
  s_add_u32 s68, s37, 0
  buffer_load_dwordx4 v4, s[20:23], s68 offen lds
  s_add_u32 m0, s78, 28672
  s_add_u32 s68, s37, 32768
  buffer_load_dwordx4 v4, s[20:23], s68 offen lds
  s_waitcnt vmcnt(9)
  v_mov_b32 v26, s58
  v_mov_b32 v27, 0
  s_mov_b64 exec, 1
  s_cmp_lg_u32 s46, 0
  s_cbranch_scc1 L_r2
  buffer_store_dword v26, v27, s[16:19], s6 offen
L_r2_x:
  s_mov_b64 exec, -1
  s_add_u32 m0, s78, 32768
  s_add_u32 s37, s67, 4
  s_and_b32 s37, s37, 7
  s_lshl_b32 s37, s37, 17
  s_add_u32 s37, s37, s36
  s_add_u32 s68, s37, 0
  buffer_load_dwordx4 v4, s[20:23], s68 offen lds
  s_add_u32 m0, s78, 36864
  s_add_u32 s68, s37, 32768
  buffer_load_dwordx4 v4, s[20:23], s68 offen lds
  s_add_u32 m0, s78, 40960
  s_add_u32 s37, s67, 5
  s_and_b32 s37, s37, 7
  s_lshl_b32 s37, s37, 17
  s_add_u32 s37, s37, s36
  s_add_u32 s68, s37, 0
  buffer_load_dwordx4 v4, s[20:23], s68 offen lds
  s_add_u32 m0, s78, 45056
  s_add_u32 s68, s37, 32768
  buffer_load_dwordx4 v4, s[20:23], s68 offen lds
  s_add_u32 m0, s78, 49152
  s_add_u32 s37, s67, 6
  s_and_b32 s37, s37, 7
  s_lshl_b32 s37, s37, 17
  s_add_u32 s37, s37, s36
  s_add_u32 s68, s37, 0
  buffer_load_dwordx4 v4, s[20:23], s68 offen lds
  s_add_u32 m0, s78, 53248
  s_add_u32 s68, s37, 32768
  buffer_load_dwordx4 v4, s[20:23], s68 offen lds
  s_add_u32 m0, s78, 57344
  s_add_u32 s37, s67, 7
  s_and_b32 s37, s37, 7
  s_lshl_b32 s37, s37, 17
  s_add_u32 s37, s37, s36
  s_add_u32 s68, s37, 0
  buffer_load_dwordx4 v4, s[20:23], s68 offen lds
  s_add_u32 m0, s78, 61440
  s_add_u32 s68, s37, 32768
  buffer_load_dwordx4 v4, s[20:23], s68 offen lds
  s_add_u32 m0, s78, 65536
  s_add_u32 s37, s67, 0
  s_and_b32 s37, s37, 7
  s_lshl_b32 s37, s37, 17
  s_add_u32 s37, s37, s36
  s_add_u32 s68, s37, 65536
  buffer_load_dwordx4 v4, s[20:23], s68 offen lds
  s_add_u32 m0, s78, 69632
  s_add_u32 s68, s37, 98304
  buffer_load_dwordx4 v4, s[20:23], s68 offen lds
  s_add_u32 s37, s67, 6
  s_and_b32 s37, s37, 7
  s_lshl_b32 s37, s37, 17
  s_add_u32 s37, s37, s36
  s_add_u32 s68, s37, 65536
  buffer_load_dwordx4 v[144:147], v4, s[20:23], s68 offen
  s_add_u32 s68, s37, 98304
  buffer_load_dwordx4 v[148:151], v4, s[20:23], s68 offen
  s_add_u32 s37, s67, 7
  s_and_b32 s37, s37, 7
  s_lshl_b32 s37, s37, 17
  s_add_u32 s37, s37, s36
  s_add_u32 s68, s37, 65536
  buffer_load_dwordx4 v[152:155], v4, s[20:23], s68 offen
  s_add_u32 s68, s37, 98304
  buffer_load_dwordx4 v[156:159], v4, s[20:23], s68 offen
  s_add_u32 s68, s48, 0
  s_cmp_ge_u32 s68, s49
  s_cselect_b32 s69, 360448, 0
  s_sub_u32 s68, s68, s69
  buffer_load_dwordx4 v[160:163], v4, s[20:23], s68 offen
  s_add_u32 s68, s48, 32768
  s_cmp_ge_u32 s68, s49
  s_cselect_b32 s69, 360448, 0
  s_sub_u32 s68, s68, s69
  buffer_load_dwordx4 v[164:167], v4, s[20:23], s68 offen
  s_add_u32 s68, s48, 65536
  s_cmp_ge_u32 s68, s49
  s_cselect_b32 s69, 360448, 0
  s_sub_u32 s68, s68, s69
  buffer_load_dwordx4 v[168:171], v4, s[20:23], s68 offen
  s_add_u32 s68, s48, 98304
  s_cmp_ge_u32 s68, s49
  s_cselect_b32 s69, 360448, 0
  s_sub_u32 s68, s68, s69
  buffer_load_dwordx4 v[172:175], v4, s[20:23], s68 offen
  s_add_u32 s68, s48, 131072
  s_cmp_ge_u32 s68, s49
  s_cselect_b32 s69, 360448, 0
  s_sub_u32 s68, s68, s69
  buffer_load_dwordx4 v[176:179], v4, s[20:23], s68 offen
  s_add_u32 s68, s48, 163840
  s_cmp_ge_u32 s68, s49
  s_cselect_b32 s69, 360448, 0
  s_sub_u32 s68, s68, s69
  buffer_load_dwordx4 v[180:183], v4, s[20:23], s68 offen
  s_sub_u32 s6, s6, 16384
  s_cmp_lt_u32 s62, 3
  s_cbranch_scc0 L_lB1
  s_add_u32 s68, s48, 196608
  s_cmp_ge_u32 s68, s49
  s_cselect_b32 s69, 360448, 0
  s_sub_u32 s68, s68, s69
  buffer_load_dwordx4 v[48:51], v4, s[20:23], s68 offen
  s_add_u32 s68, s48, 229376
  s_cmp_ge_u32 s68, s49
  s_cselect_b32 s69, 360448, 0
  s_sub_u32 s68, s68, s69
  buffer_load_dwordx4 v[52:55], v4, s[20:23], s68 offen
  s_add_u32 s68, s48, 262144
  s_cmp_ge_u32 s68, s49
  s_cselect_b32 s69, 360448, 0
  s_sub_u32 s68, s68, s69
  buffer_load_dwordx4 v[56:59], v4, s[20:23], s68 offen
  s_add_u32 s68, s48, 294912
  s_cmp_ge_u32 s68, s49
  s_cselect_b32 s69, 360448, 0
  s_sub_u32 s68, s68, s69
  buffer_load_dwordx4 v[60:63], v4, s[20:23], s68 offen
  s_add_u32 s68, s48, 327680
  s_cmp_ge_u32 s68, s49
  s_cselect_b32 s69, 360448, 0
  s_sub_u32 s68, s68, s69
  buffer_load_dwordx4 v[64:67], v4, s[20:23], s68 offen
  s_waitcnt vmcnt(15)
  v_mov_b32 v26, 3
  s_mov_b64 exec, 1
  ds_write_b32 v11, v26
  s_mov_b64 exec, -1
  ds_read_b32 v28, v24
  s_waitcnt lgkmcnt(0)
  v_cmp_gt_u32 vcc, 8, v28
  s_nop 1
  s_cbranch_vccz L_w5_x
  s_mov_b32 s71, 1048576
L_w5:
  ds_read_b32 v28, v24
  s_sub_u32 s71, s71, 1
  s_waitcnt lgkmcnt(0)
  v_cmp_gt_u32 vcc, 8, v28
  s_cbranch_scc1 L_w5_x
  s_nop 0
  s_cbranch_vccnz L_w5
L_w5_x:
  ds_write_b128 v9, v[104:107] offset:32768
  ds_write_b128 v9, v[108:111] offset:36864
  ds_write_b128 v9, v[112:115] offset:40960
  ds_write_b128 v9, v[116:119] offset:45056
  ds_read_b32 v28, v22
  s_waitcnt lgkmcnt(0)
  v_cmp_gt_u32 vcc, 9, v28
  s_nop 1
  s_cbranch_vccz L_w6_x
  s_mov_b32 s71, 1048576
L_w6:
  ds_read_b32 v28, v22
  s_sub_u32 s71, s71, 1
  s_waitcnt lgkmcnt(0)
  v_cmp_gt_u32 vcc, 9, v28
  s_cbranch_scc1 L_w6_x
  s_nop 0
  s_cbranch_vccnz L_w6
L_w6_x:
  ds_read_b128 v[32:35], v9 offset:8192
  ds_read_b128 v[36:39], v9 offset:12288
  s_waitcnt lgkmcnt(1)
  buffer_store_dwordx4 v[32:35], v23, s[16:19], s5 offen offset:0 sc1
  s_waitcnt lgkmcnt(0)
  buffer_store_dwordx4 v[36:39], v23, s[16:19], s5 offen offset:1024 sc1
  ds_write_b128 v9, v[120:123] offset:49152
  ds_write_b128 v9, v[124:127] offset:53248
  ds_read_b32 v28, v22
  s_waitcnt lgkmcnt(0)
  v_cmp_gt_u32 vcc, 10, v28
  s_nop 1
  s_cbranch_vccz L_w7_x
  s_mov_b32 s71, 1048576
L_w7:
  ds_read_b32 v28, v22
  s_sub_u32 s71, s71, 1
  s_waitcnt lgkmcnt(0)
  v_cmp_gt_u32 vcc, 10, v28
  s_cbranch_scc1 L_w7_x
  s_nop 0
  s_cbranch_vccnz L_w7
L_w7_x:
  ds_read_b128 v[40:43], v9 offset:16384
  ds_read_b128 v[44:47], v9 offset:20480
  s_waitcnt lgkmcnt(1)
  buffer_store_dwordx4 v[40:43], v23, s[16:19], s5 offen offset:2048 sc1
  s_waitcnt lgkmcnt(0)
  buffer_store_dwordx4 v[44:47], v23, s[16:19], s5 offen offset:3072 sc1
  ds_write_b128 v9, v[128:131] offset:57344
  ds_write_b128 v9, v[132:135] offset:61440
  ds_write_b128 v10, v[136:139] offset:0
  ds_write_b128 v10, v[140:143] offset:4096
  s_waitcnt vmcnt(18)
  ds_write_b128 v10, v[144:147] offset:8192
  s_waitcnt vmcnt(17)
  ds_write_b128 v10, v[148:151] offset:12288
  s_waitcnt vmcnt(16)
  ds_write_b128 v10, v[152:155] offset:16384
  s_waitcnt vmcnt(15)
  ds_write_b128 v10, v[156:159] offset:20480
  s_waitcnt vmcnt(14)
  ds_write_b128 v9, v[160:163] offset:24576
  s_waitcnt vmcnt(13)
  ds_write_b128 v9, v[164:167] offset:28672
  s_waitcnt vmcnt(12)
  ds_write_b128 v9, v[168:171] offset:8192
  s_waitcnt vmcnt(11)
  ds_write_b128 v9, v[172:175] offset:12288
  s_waitcnt vmcnt(10)
  ds_write_b128 v9, v[176:179] offset:16384
  s_waitcnt vmcnt(9)
  ds_write_b128 v9, v[180:183] offset:20480
  s_waitcnt lgkmcnt(0)
  v_mov_b32 v26, 4
  s_mov_b64 exec, 1
  ds_write_b32 v11, v26
  s_mov_b64 exec, -1
  s_waitcnt vmcnt(0)
  v_mov_b32 v26, s58
  v_mov_b32 v27, 0
  s_mov_b64 exec, 1
  s_cmp_lg_u32 s46, 0
  s_cbranch_scc1 L_r3
  buffer_store_dword v26, v27, s[16:19], s6 offen
L_r3_x:
  s_mov_b64 exec, -1
  s_add_u32 s37, s3, 0
  s_and_b32 s37, s37, 3
  s_lshl_b32 s37, s37, 17
  s_add_u32 s37, s37, s36
  s_add_u32 s68, s37, 0
  buffer_load_dwordx4 v[68:71], v4, s[24:27], s68 offen
  s_add_u32 s68, s37, 32768
  buffer_load_dwordx4 v[72:75], v4, s[24:27], s68 offen
  s_add_u32 s68, s37, 65536
  buffer_load_dwordx4 v[76:79], v4, s[24:27], s68 offen
  s_add_u32 s68, s37, 98304
  buffer_load_dwordx4 v[80:83], v4, s[24:27], s68 offen
  s_branch L_l5
L_lB1:
  s_waitcnt vmcnt(10)
  v_mov_b32 v26, 3
  s_mov_b64 exec, 1
  ds_write_b32 v11, v26
  s_mov_b64 exec, -1
  ds_read_b32 v28, v24
  s_waitcnt lgkmcnt(0)
  v_cmp_gt_u32 vcc, 8, v28
  s_nop 1
  s_cbranch_vccz L_w8_x
  s_mov_b32 s71, 1048576
L_w8:
  ds_read_b32 v28, v24
  s_sub_u32 s71, s71, 1
  s_waitcnt lgkmcnt(0)
  v_cmp_gt_u32 vcc, 8, v28
  s_cbranch_scc1 L_w8_x
  s_nop 0
  s_cbranch_vccnz L_w8
L_w8_x:
  ds_write_b128 v9, v[104:107] offset:32768
  ds_write_b128 v9, v[108:111] offset:36864
  ds_write_b128 v9, v[112:115] offset:40960
  ds_write_b128 v9, v[116:119] offset:45056
  ds_read_b32 v28, v22
  s_waitcnt lgkmcnt(0)
  v_cmp_gt_u32 vcc, 9, v28
  s_nop 1
  s_cbranch_vccz L_w9_x
  s_mov_b32 s71, 1048576
L_w9:
  ds_read_b32 v28, v22
  s_sub_u32 s71, s71, 1
  s_waitcnt lgkmcnt(0)
  v_cmp_gt_u32 vcc, 9, v28
  s_cbranch_scc1 L_w9_x
  s_nop 0
  s_cbranch_vccnz L_w9
L_w9_x:
  ds_read_b128 v[32:35], v9 offset:8192
  ds_read_b128 v[36:39], v9 offset:12288
  s_waitcnt lgkmcnt(1)
  buffer_store_dwordx4 v[32:35], v23, s[16:19], s5 offen offset:0 sc1
  s_waitcnt lgkmcnt(0)
  buffer_store_dwordx4 v[36:39], v23, s[16:19], s5 offen offset:1024 sc1
  ds_write_b128 v9, v[120:123] offset:49152
  ds_write_b128 v9, v[124:127] offset:53248
  ds_write_b128 v9, v[128:131] offset:57344
  ds_write_b128 v9, v[132:135] offset:61440
  ds_write_b128 v10, v[136:139] offset:0
  ds_write_b128 v10, v[140:143] offset:4096
  s_waitcnt vmcnt(11)
  ds_write_b128 v10, v[144:147] offset:8192
  s_waitcnt vmcnt(10)
  ds_write_b128 v10, v[148:151] offset:12288
  s_waitcnt vmcnt(9)
  ds_write_b128 v10, v[152:155] offset:16384
  s_waitcnt vmcnt(8)
  ds_write_b128 v10, v[156:159] offset:20480
  s_waitcnt vmcnt(7)
  ds_write_b128 v9, v[160:163] offset:24576
  s_waitcnt vmcnt(6)
  ds_write_b128 v9, v[164:167] offset:28672
  s_waitcnt vmcnt(5)
  ds_write_b128 v9, v[168:171] offset:8192
  s_waitcnt vmcnt(4)
  ds_write_b128 v9, v[172:175] offset:12288
  s_waitcnt vmcnt(3)
  ds_write_b128 v9, v[176:179] offset:16384
  s_waitcnt vmcnt(2)
  ds_write_b128 v9, v[180:183] offset:20480
  s_waitcnt lgkmcnt(0)
  v_mov_b32 v26, 4
  s_mov_b64 exec, 1
  ds_write_b32 v11, v26
  s_mov_b64 exec, -1
  s_waitcnt vmcnt(0)
  v_mov_b32 v26, s58
  v_mov_b32 v27, 0
  s_mov_b64 exec, 1
  s_cmp_lg_u32 s46, 0
  s_cbranch_scc1 L_r4
  buffer_store_dword v26, v27, s[16:19], s6 offen
L_r4_x:
  s_mov_b64 exec, -1
  s_add_u32 s68, s48, 196608
  s_cmp_ge_u32 s68, s49
  s_cselect_b32 s69, 360448, 0
  s_sub_u32 s68, s68, s69
  buffer_load_dwordx4 v[48:51], v4, s[20:23], s68 offen
  s_add_u32 s68, s48, 229376
  s_cmp_ge_u32 s68, s49
  s_cselect_b32 s69, 360448, 0
  s_sub_u32 s68, s68, s69
  buffer_load_dwordx4 v[52:55], v4, s[20:23], s68 offen
  s_add_u32 s68, s48, 262144
  s_cmp_ge_u32 s68, s49
  s_cselect_b32 s69, 360448, 0
  s_sub_u32 s68, s68, s69
  buffer_load_dwordx4 v[56:59], v4, s[20:23], s68 offen
  s_add_u32 s68, s48, 294912
  s_cmp_ge_u32 s68, s49
  s_cselect_b32 s69, 360448, 0
  s_sub_u32 s68, s68, s69
  buffer_load_dwordx4 v[60:63], v4, s[20:23], s68 offen
  s_add_u32 s68, s48, 327680
  s_cmp_ge_u32 s68, s49
  s_cselect_b32 s69, 360448, 0
  s_sub_u32 s68, s68, s69
  buffer_load_dwordx4 v[64:67], v4, s[20:23], s68 offen
  s_add_u32 s37, s3, 0
  s_and_b32 s37, s37, 3
  s_lshl_b32 s37, s37, 17
  s_add_u32 s37, s37, s36
  s_add_u32 s68, s37, 0
  buffer_load_dwordx4 v[68:71], v4, s[24:27], s68 offen
  s_add_u32 s68, s37, 32768
  buffer_load_dwordx4 v[72:75], v4, s[24:27], s68 offen
  s_add_u32 s68, s37, 65536
  buffer_load_dwordx4 v[76:79], v4, s[24:27], s68 offen
  s_add_u32 s68, s37, 98304
  buffer_load_dwordx4 v[80:83], v4, s[24:27], s68 offen
  s_waitcnt vmcnt(4)
  s_branch L_l5
L_lA:
  s_mul_i32 s44, s60, 483328
  s_lshl_b32 s69, s62, 12
  s_add_u32 s44, s44, s69
  s_add_u32 s44, s44, s78
  s_add_u32 s44, s44, 0x155800
  s_add_u32 s37, s67, 1
  s_and_b32 s37, s37, 7
  s_lshl_b32 s37, s37, 17
  s_add_u32 s37, s37, s36
  s_add_u32 s68, s37, 65536
  buffer_load_dwordx4 v[104:107], v4, s[20:23], s68 offen
  s_add_u32 s68, s37, 98304
  buffer_load_dwordx4 v[108:111], v4, s[20:23], s68 offen
  s_add_u32 s37, s67, 2
  s_and_b32 s37, s37, 7
  s_lshl_b32 s37, s37, 17
  s_add_u32 s37, s37, s36
  s_add_u32 s68, s37, 65536
  buffer_load_dwordx4 v[112:115], v4, s[20:23], s68 offen
  s_add_u32 s68, s37, 98304
  buffer_load_dwordx4 v[116:119], v4, s[20:23], s68 offen
  s_add_u32 s37, s67, 3
  s_and_b32 s37, s37, 7
  s_lshl_b32 s37, s37, 17
  s_add_u32 s37, s37, s36
  s_add_u32 s68, s37, 65536
  buffer_load_dwordx4 v[120:123], v4, s[20:23], s68 offen
  s_add_u32 s68, s37, 98304
  buffer_load_dwordx4 v[124:127], v4, s[20:23], s68 offen
  s_add_u32 s37, s67, 4
  s_and_b32 s37, s37, 7
  s_lshl_b32 s37, s37, 17
  s_add_u32 s37, s37, s36
  s_add_u32 s68, s37, 65536
  buffer_load_dwordx4 v[128:131], v4, s[20:23], s68 offen
  s_add_u32 s68, s37, 98304
  buffer_load_dwordx4 v[132:135], v4, s[20:23], s68 offen
  s_waitcnt vmcnt(22)
  ds_write_b128 v9, v[48:51] offset:40960
  ds_write_b128 v9, v[52:55] offset:45056
  s_waitcnt vmcnt(20)
  ds_write_b128 v9, v[56:59] offset:49152
  ds_write_b128 v9, v[60:63] offset:53248
  s_waitcnt vmcnt(18)
  ds_write_b128 v9, v[64:67] offset:57344
  ds_write_b128 v9, v[68:71] offset:61440
  s_waitcnt vmcnt(16)
  ds_write_b128 v10, v[72:75] offset:0
  ds_write_b128 v10, v[76:79] offset:4096
  s_waitcnt vmcnt(14)
  ds_write_b128 v10, v[80:83] offset:8192
  ds_write_b128 v10, v[84:87] offset:12288
  s_waitcnt vmcnt(12)
  ds_write_b128 v10, v[88:91] offset:16384
  ds_write_b128 v10, v[92:95] offset:20480
  s_waitcnt vmcnt(10)
  ds_write_b128 v9, v[96:99] offset:24576
  ds_write_b128 v9, v[100:103] offset:28672
  s_waitcnt lgkmcnt(0)
  v_mov_b32 v26, 1
  s_mov_b64 exec, 1
  ds_write_b32 v11, v26
  s_mov_b64 exec, -1
  s_add_u32 s37, s67, 5
  s_and_b32 s37, s37, 7
  s_lshl_b32 s37, s37, 17
  s_add_u32 s37, s37, s36
  s_add_u32 s68, s37, 65536
  buffer_load_dwordx4 v[136:139], v4, s[20:23], s68 offen
  s_add_u32 s68, s37, 98304
  buffer_load_dwordx4 v[140:143], v4, s[20:23], s68 offen
  s_add_u32 s37, s67, 6
  s_and_b32 s37, s37, 7
  s_lshl_b32 s37, s37, 17
  s_add_u32 s37, s37, s36
  s_add_u32 s68, s37, 65536
  buffer_load_dwordx4 v[144:147], v4, s[20:23], s68 offen
  s_add_u32 s68, s37, 98304
  buffer_load_dwordx4 v[148:151], v4, s[20:23], s68 offen
  s_add_u32 s37, s67, 7
  s_and_b32 s37, s37, 7
  s_lshl_b32 s37, s37, 17
  s_add_u32 s37, s37, s36
  s_add_u32 s68, s37, 65536
  buffer_load_dwordx4 v[152:155], v4, s[20:23], s68 offen
  s_add_u32 s68, s37, 98304
  buffer_load_dwordx4 v[156:159], v4, s[20:23], s68 offen
  s_add_u32 s68, s48, 0
  s_cmp_ge_u32 s68, s49
  s_cselect_b32 s69, 360448, 0
  s_sub_u32 s68, s68, s69
  buffer_load_dwordx4 v[160:163], v4, s[20:23], s68 offen
  s_add_u32 s68, s48, 32768
  s_cmp_ge_u32 s68, s49
  s_cselect_b32 s69, 360448, 0
  s_sub_u32 s68, s68, s69
  buffer_load_dwordx4 v[164:167], v4, s[20:23], s68 offen
  s_add_u32 s68, s48, 65536
  s_cmp_ge_u32 s68, s49
  s_cselect_b32 s69, 360448, 0
  s_sub_u32 s68, s68, s69
  buffer_load_dwordx4 v[168:171], v4, s[20:23], s68 offen
  s_add_u32 s68, s48, 98304
  s_cmp_ge_u32 s68, s49
  s_cselect_b32 s69, 360448, 0
  s_sub_u32 s68, s68, s69
  buffer_load_dwordx4 v[172:175], v4, s[20:23], s68 offen
  s_add_u32 s68, s48, 131072
  s_cmp_ge_u32 s68, s49
  s_cselect_b32 s69, 360448, 0
  s_sub_u32 s68, s68, s69
  buffer_load_dwordx4 v[176:179], v4, s[20:23], s68 offen
  s_add_u32 s68, s48, 163840
  s_cmp_ge_u32 s68, s49
  s_cselect_b32 s69, 360448, 0
  s_sub_u32 s68, s68, s69
  buffer_load_dwordx4 v[180:183], v4, s[20:23], s68 offen
  ds_read_b32 v28, v24
  s_waitcnt lgkmcnt(0)
  v_cmp_gt_u32 vcc, 2, v28
  s_nop 1
  s_cbranch_vccz L_w10_x
  s_mov_b32 s71, 1048576
L_w10:
  ds_read_b32 v28, v24
  s_sub_u32 s71, s71, 1
  s_waitcnt lgkmcnt(0)
  v_cmp_gt_u32 vcc, 2, v28
  s_cbranch_scc1 L_w10_x
  s_nop 0
  s_cbranch_vccnz L_w10
L_w10_x:
  ds_read_b32 v28, v24 offset:32
  s_waitcnt lgkmcnt(0)
  v_cmp_ne_u32 vcc, 0, v28
  s_nop 1
  s_or_b32 s46, vcc_lo, vcc_hi
  s_add_u32 m0, s78, 0
  s_add_u32 s37, s67, 0
  s_and_b32 s37, s37, 7
  s_lshl_b32 s37, s37, 17
  s_add_u32 s37, s37, s36
  s_add_u32 s68, s37, 0
  buffer_load_dwordx4 v4, s[20:23], s68 offen lds
  s_add_u32 m0, s78, 4096
  s_add_u32 s68, s37, 32768
  buffer_load_dwordx4 v4, s[20:23], s68 offen lds
  s_add_u32 m0, s78, 8192
  s_add_u32 s37, s67, 1
  s_and_b32 s37, s37, 7
  s_lshl_b32 s37, s37, 17
  s_add_u32 s37, s37, s36
  s_add_u32 s68, s37, 0
  buffer_load_dwordx4 v4, s[20:23], s68 offen lds
  s_add_u32 m0, s78, 12288
  s_add_u32 s68, s37, 32768
  buffer_load_dwordx4 v4, s[20:23], s68 offen lds
  s_add_u32 m0, s78, 16384
  s_add_u32 s37, s67, 2
  s_and_b32 s37, s37, 7
  s_lshl_b32 s37, s37, 17
  s_add_u32 s37, s37, s36
  s_add_u32 s68, s37, 0
  buffer_load_dwordx4 v4, s[20:23], s68 offen lds
  s_add_u32 m0, s78, 20480
  s_add_u32 s68, s37, 32768
  buffer_load_dwordx4 v4, s[20:23], s68 offen lds
  s_add_u32 m0, s78, 24576
  s_add_u32 s37, s67, 3
  s_and_b32 s37, s37, 7
  s_lshl_b32 s37, s37, 17
  s_add_u32 s37, s37, s36
  s_add_u32 s68, s37, 0
  buffer_load_dwordx4 v4, s[20:23], s68 offen lds
  s_add_u32 m0, s78, 28672
  s_add_u32 s68, s37, 32768
  buffer_load_dwordx4 v4, s[20:23], s68 offen lds
  s_add_u32 m0, s78, 32768
  s_add_u32 s37, s67, 4
  s_and_b32 s37, s37, 7
  s_lshl_b32 s37, s37, 17
  s_add_u32 s37, s37, s36
  s_add_u32 s68, s37, 0
  buffer_load_dwordx4 v4, s[20:23], s68 offen lds
  s_add_u32 m0, s78, 36864
  s_add_u32 s68, s37, 32768
  buffer_load_dwordx4 v4, s[20:23], s68 offen lds
  s_add_u32 m0, s78, 40960
  s_add_u32 s37, s67, 5
  s_and_b32 s37, s37, 7
  s_lshl_b32 s37, s37, 17
  s_add_u32 s37, s37, s36
  s_add_u32 s68, s37, 0
  buffer_load_dwordx4 v4, s[20:23], s68 offen lds
  s_add_u32 m0, s78, 45056
  s_add_u32 s68, s37, 32768
  buffer_load_dwordx4 v4, s[20:23], s68 offen lds
  s_add_u32 m0, s78, 49152
  s_add_u32 s37, s67, 6
  s_and_b32 s37, s37, 7
  s_lshl_b32 s37, s37, 17
  s_add_u32 s37, s37, s36
  s_add_u32 s68, s37, 0
  buffer_load_dwordx4 v4, s[20:23], s68 offen lds
  s_add_u32 m0, s78, 53248
  s_add_u32 s68, s37, 32768
  buffer_load_dwordx4 v4, s[20:23], s68 offen lds
  s_add_u32 m0, s78, 57344
  s_add_u32 s37, s67, 7
  s_and_b32 s37, s37, 7
  s_lshl_b32 s37, s37, 17
  s_add_u32 s37, s37, s36
  s_add_u32 s68, s37, 0
  buffer_load_dwordx4 v4, s[20:23], s68 offen lds
  s_add_u32 m0, s78, 61440
  s_add_u32 s68, s37, 32768
  buffer_load_dwordx4 v4, s[20:23], s68 offen lds
  s_add_u32 m0, s78, 65536
  s_add_u32 s37, s67, 0
  s_and_b32 s37, s37, 7
  s_lshl_b32 s37, s37, 17
  s_add_u32 s37, s37, s36
  s_add_u32 s68, s37, 65536
  buffer_load_dwordx4 v4, s[20:23], s68 offen lds
  s_add_u32 m0, s78, 69632
  s_add_u32 s68, s37, 98304
  buffer_load_dwordx4 v4, s[20:23], s68 offen lds
  v_and_b32 v23, 15, v0
  v_lshlrev_b32 v27, 4, v0
  v_lshrrev_b32 v22, 2, v0
  v_mul_u32_u24 v25, 4352, v22
  v_and_b32 v26, 3, v0
  v_lshl_add_u32 v25, v26, 4, v25
  s_mul_i32 s5, s62, 69632
  s_add_u32 s5, s5, 0x10000
  s_lshl_b32 s4, s59, 6
  s_add_u32 s4, s4, s5
  s_add_u32 s4, s4, 4096
  s_add_u32 s5, s5, s78
  s_add_u32 s7, s5, 69632
  s_lshl_b32 s6, s60, 1
  s_and_b32 s6, s6, 15
  s_mul_i32 s6, s6, 4352
  s_add_u32 s6, s6, s5
  s_add_u32 s68, s78, 0x27000
  v_and_b32 v40, 1, v26
  v_lshlrev_b32 v40, 4, v40
  v_lshrrev_b32 v26, 1, v26
  v_lshl_or_b32 v40, v26, 3, v40
  v_lshl_or_b32 v40, v22, 5, v40
  v_add_u32 v40, s68, v40
  v_bfe_u32 v41, v0, 4, 1
  v_lshlrev_b32 v41, 4, v41
  v_lshrrev_b32 v26, 5, v0
  v_lshl_or_b32 v41, v26, 3, v41
  v_lshl_or_b32 v41, v23, 5, v41
  v_add_u32 v41, s68, v41
  v_and_b32 v42, 31, v0
  v_lshlrev_b32 v42, 5, v42
  v_lshl_or_b32 v42, v26, 4, v42
  v_add_u32 v42, s68, v42
  s_lshr_b32 s39, s58, 8
  s_lshr_b32 s42, s58, 16
  s_lshr_b32 s43, s58, 24
  s_setprio 3
  s_mov_b32 s70, 32
L_kvall:
  s_mov_b32 s71, 65536
L_kv:
  buffer_load_dwordx4 v[28:31], v25, s[16:19], s4 offen sc1
  s_waitcnt vmcnt(0)
  v_xor_b32 v20, s58, v28
  v_xor_b32 v21, s39, v29
  v_bitop3_b32 v20, v20, v30, s42 bitop3:0xf6
  v_bitop3_b32 v21, v21, v31, s43 bitop3:0xf6
  v_or_b32 v20, v20, v21
  v_and_b32 v20, 0xff, v20
  v_cmp_ne_u32 vcc, 0, v20
  s_sub_u32 s71, s71, 1
  s_cbranch_scc1 L_kv_x
  s_cbranch_vccz L_kv_x
  s_sleep 2
  s_branch L_kv
L_kv_x:
  v_mov_b32 v26, 3
  s_mov_b64 exec, 1
  ds_write_b32 v11, v26
  s_mov_b64 exec, -1
  s_mov_b32 s69, s6
  buffer_load_dwordx4 v[48:51], v27, s[16:19], s69 offen sc1
  s_add_u32 s69, s69, 4352
  buffer_load_dwordx4 v[52:55], v27, s[16:19], s69 offen sc1
  s_add_u32 s69, s69, 4352
  s_cmp_eq_u32 s69, s7
  s_cselect_b32 s69, s5, s69
  buffer_load_dwordx4 v[56:59], v27, s[16:19], s69 offen sc1
  s_add_u32 s69, s69, 4352
  buffer_load_dwordx4 v[60:63], v27, s[16:19], s69 offen sc1
  s_add_u32 s69, s69, 4352
  s_cmp_eq_u32 s69, s7
  s_cselect_b32 s69, s5, s69
  buffer_load_dwordx4 v[64:67], v27, s[16:19], s69 offen sc1
  s_add_u32 s69, s69, 4352
  buffer_load_dwordx4 v[68:71], v27, s[16:19], s69 offen sc1
  s_add_u32 s69, s69, 4352
  s_cmp_eq_u32 s69, s7
  s_cselect_b32 s69, s5, s69
  buffer_load_dwordx4 v[72:75], v27, s[16:19], s69 offen sc1
  s_add_u32 s69, s69, 4352
  buffer_load_dwordx4 v[76:79], v27, s[16:19], s69 offen sc1
  s_add_u32 s69, s69, 4352
  s_cmp_eq_u32 s69, s7
  s_cselect_b32 s69, s5, s69
  buffer_load_dwordx4 v[80:83], v27, s[16:19], s69 offen sc1
  s_add_u32 s69, s69, 4352
  buffer_load_dwordx4 v[84:87], v27, s[16:19], s69 offen sc1
  s_add_u32 s69, s69, 4352
  s_cmp_eq_u32 s69, s7
  s_cselect_b32 s69, s5, s69
  buffer_load_dwordx4 v[88:91], v27, s[16:19], s69 offen sc1
  s_add_u32 s69, s69, 4352
  buffer_load_dwordx4 v[92:95], v27, s[16:19], s69 offen sc1
  s_add_u32 s69, s69, 4352
  s_cmp_eq_u32 s69, s7
  s_cselect_b32 s69, s5, s69
  buffer_load_dwordx4 v[96:99], v27, s[16:19], s69 offen sc1
  s_add_u32 s69, s69, 4352
  buffer_load_dwordx4 v[100:103], v27, s[16:19], s69 offen sc1
  s_add_u32 s69, s69, 4352
  s_cmp_eq_u32 s69, s7
  s_cselect_b32 s69, s5, s69
  buffer_load_dwordx4 v[184:187], v27, s[16:19], s69 offen sc1
  s_add_u32 s69, s69, 4352
  buffer_load_dwordx4 v[188:191], v27, s[16:19], s69 offen sc1
  v_and_b32 v28, 0xffffff00, v28
  v_and_b32 v29, 0xffffff00, v29
  v_and_b32 v30, 0xffffff00, v30
  v_and_b32 v31, 0xffffff00, v31
  v_add_f32_dpp v28, v28, v28 row_ror:4 row_mask:0xf bank_mask:0xf
  v_add_f32_dpp v29, v29, v29 row_ror:4 row_mask:0xf bank_mask:0xf
  v_add_f32_dpp v30, v30, v30 row_ror:4 row_mask:0xf bank_mask:0xf
  v_add_f32_dpp v31, v31, v31 row_ror:4 row_mask:0xf bank_mask:0xf
  v_add_f32_dpp v28, v28, v28 row_ror:8 row_mask:0xf bank_mask:0xf
  v_add_f32_dpp v29, v29, v29 row_ror:8 row_mask:0xf bank_mask:0xf
  v_add_f32_dpp v30, v30, v30 row_ror:8 row_mask:0xf bank_mask:0xf
  v_add_f32_dpp v31, v31, v31 row_ror:8 row_mask:0xf bank_mask:0xf
  v_mov_b32 v32, v28
  v_mov_b32 v33, v29
  v_mov_b32 v34, v30
  v_mov_b32 v35, v31
  v_permlane16_swap_b32 v28, v32
  v_permlane16_swap_b32 v29, v33
  v_permlane16_swap_b32 v30, v34
  v_permlane16_swap_b32 v31, v35
  v_add_f32 v28, v28, v32
  v_add_f32 v29, v29, v33
  v_add_f32 v30, v30, v34
  v_add_f32 v31, v31, v35
  v_mov_b32 v32, v28
  v_mov_b32 v33, v29
  v_mov_b32 v34, v30
  v_mov_b32 v35, v31
  v_permlane32_swap_b32 v28, v32
  v_permlane32_swap_b32 v29, v33
  v_permlane32_swap_b32 v30, v34
  v_permlane32_swap_b32 v31, v35
  v_add_f32 v28, v28, v32
  v_add_f32 v29, v29, v33
  v_add_f32 v30, v30, v34
  v_add_f32 v31, v31, v35
  v_cvt_pk_bf16_f32 v28, v28, v29
  v_cvt_pk_bf16_f32 v29, v30, v31
  ds_write_b64 v40, v[28:29] offset:512
  s_waitcnt vmcnt(15)
  v_xor_b32 v36, s58, v48
  v_and_b32 v32, 0xffffff00, v48
  v_xor_b32 v37, s39, v49
  v_and_b32 v33, 0xffffff00, v49
  v_xor_b32 v38, s42, v50
  v_and_b32 v34, 0xffffff00, v50
  v_xor_b32 v39, s43, v51
  v_and_b32 v35, 0xffffff00, v51
  s_waitcnt vmcnt(14)
  v_bitop3_b32 v36, v36, v52, s58 bitop3:0xf6
  v_and_b32 v44, 0xffffff00, v52
  v_bitop3_b32 v37, v37, v53, s39 bitop3:0xf6
  v_and_b32 v45, 0xffffff00, v53
  v_bitop3_b32 v38, v38, v54, s42 bitop3:0xf6
  v_and_b32 v46, 0xffffff00, v54
  v_bitop3_b32 v39, v39, v55, s43 bitop3:0xf6
  v_and_b32 v47, 0xffffff00, v55
  v_add_f32 v32, v32, v44
  v_add_f32 v33, v33, v45
  v_add_f32 v34, v34, v46
  v_add_f32 v35, v35, v47
  s_waitcnt vmcnt(13)
  v_bitop3_b32 v36, v36, v56, s58 bitop3:0xf6
  v_and_b32 v44, 0xffffff00, v56
  v_bitop3_b32 v37, v37, v57, s39 bitop3:0xf6
  v_and_b32 v45, 0xffffff00, v57
  v_bitop3_b32 v38, v38, v58, s42 bitop3:0xf6
  v_and_b32 v46, 0xffffff00, v58
  v_bitop3_b32 v39, v39, v59, s43 bitop3:0xf6
  v_and_b32 v47, 0xffffff00, v59
  v_add_f32 v32, v32, v44
  v_add_f32 v33, v33, v45
  v_add_f32 v34, v34, v46
  v_add_f32 v35, v35, v47
  s_waitcnt vmcnt(12)
  v_bitop3_b32 v36, v36, v60, s58 bitop3:0xf6
  v_and_b32 v44, 0xffffff00, v60
  v_bitop3_b32 v37, v37, v61, s39 bitop3:0xf6
  v_and_b32 v45, 0xffffff00, v61
  v_bitop3_b32 v38, v38, v62, s42 bitop3:0xf6
  v_and_b32 v46, 0xffffff00, v62
  v_bitop3_b32 v39, v39, v63, s43 bitop3:0xf6
  v_and_b32 v47, 0xffffff00, v63
  v_add_f32 v32, v32, v44
  v_add_f32 v33, v33, v45
  v_add_f32 v34, v34, v46
  v_add_f32 v35, v35, v47
  s_waitcnt vmcnt(11)
  v_bitop3_b32 v36, v36, v64, s58 bitop3:0xf6
  v_and_b32 v44, 0xffffff00, v64
  v_bitop3_b32 v37, v37, v65, s39 bitop3:0xf6
  v_and_b32 v45, 0xffffff00, v65
  v_bitop3_b32 v38, v38, v66, s42 bitop3:0xf6
  v_and_b32 v46, 0xffffff00, v66
  v_bitop3_b32 v39, v39, v67, s43 bitop3:0xf6
  v_and_b32 v47, 0xffffff00, v67
  v_add_f32 v32, v32, v44
  v_add_f32 v33, v33, v45
  v_add_f32 v34, v34, v46
  v_add_f32 v35, v35, v47
  s_waitcnt vmcnt(10)
  v_bitop3_b32 v36, v36, v68, s58 bitop3:0xf6
  v_and_b32 v44, 0xffffff00, v68
  v_bitop3_b32 v37, v37, v69, s39 bitop3:0xf6
  v_and_b32 v45, 0xffffff00, v69
  v_bitop3_b32 v38, v38, v70, s42 bitop3:0xf6
  v_and_b32 v46, 0xffffff00, v70
  v_bitop3_b32 v39, v39, v71, s43 bitop3:0xf6
  v_and_b32 v47, 0xffffff00, v71
  v_add_f32 v32, v32, v44
  v_add_f32 v33, v33, v45
  v_add_f32 v34, v34, v46
  v_add_f32 v35, v35, v47
  s_waitcnt vmcnt(9)
  v_bitop3_b32 v36, v36, v72, s58 bitop3:0xf6
  v_and_b32 v44, 0xffffff00, v72
  v_bitop3_b32 v37, v37, v73, s39 bitop3:0xf6
  v_and_b32 v45, 0xffffff00, v73
  v_bitop3_b32 v38, v38, v74, s42 bitop3:0xf6
  v_and_b32 v46, 0xffffff00, v74
  v_bitop3_b32 v39, v39, v75, s43 bitop3:0xf6
  v_and_b32 v47, 0xffffff00, v75
  v_add_f32 v32, v32, v44
  v_add_f32 v33, v33, v45
  v_add_f32 v34, v34, v46
  v_add_f32 v35, v35, v47
  s_waitcnt vmcnt(8)
  v_bitop3_b32 v36, v36, v76, s58 bitop3:0xf6
  v_and_b32 v44, 0xffffff00, v76
  v_bitop3_b32 v37, v37, v77, s39 bitop3:0xf6
  v_and_b32 v45, 0xffffff00, v77
  v_bitop3_b32 v38, v38, v78, s42 bitop3:0xf6
  v_and_b32 v46, 0xffffff00, v78
  v_bitop3_b32 v39, v39, v79, s43 bitop3:0xf6
  v_and_b32 v47, 0xffffff00, v79
  v_add_f32 v32, v32, v44
  v_add_f32 v33, v33, v45
  v_add_f32 v34, v34, v46
  v_add_f32 v35, v35, v47
  s_waitcnt vmcnt(7)
  v_bitop3_b32 v36, v36, v80, s58 bitop3:0xf6
  v_and_b32 v44, 0xffffff00, v80
  v_bitop3_b32 v37, v37, v81, s39 bitop3:0xf6
  v_and_b32 v45, 0xffffff00, v81
  v_bitop3_b32 v38, v38, v82, s42 bitop3:0xf6
  v_and_b32 v46, 0xffffff00, v82
  v_bitop3_b32 v39, v39, v83, s43 bitop3:0xf6
  v_and_b32 v47, 0xffffff00, v83
  v_add_f32 v32, v32, v44
  v_add_f32 v33, v33, v45
  v_add_f32 v34, v34, v46
  v_add_f32 v35, v35, v47
  s_waitcnt vmcnt(6)
  v_bitop3_b32 v36, v36, v84, s58 bitop3:0xf6
  v_and_b32 v44, 0xffffff00, v84
  v_bitop3_b32 v37, v37, v85, s39 bitop3:0xf6
  v_and_b32 v45, 0xffffff00, v85
  v_bitop3_b32 v38, v38, v86, s42 bitop3:0xf6
  v_and_b32 v46, 0xffffff00, v86
  v_bitop3_b32 v39, v39, v87, s43 bitop3:0xf6
  v_and_b32 v47, 0xffffff00, v87
  v_add_f32 v32, v32, v44
  v_add_f32 v33, v33, v45
  v_add_f32 v34, v34, v46
  v_add_f32 v35, v35, v47
  s_waitcnt vmcnt(5)
  v_bitop3_b32 v36, v36, v88, s58 bitop3:0xf6
  v_and_b32 v44, 0xffffff00, v88
  v_bitop3_b32 v37, v37, v89, s39 bitop3:0xf6
  v_and_b32 v45, 0xffffff00, v89
  v_bitop3_b32 v38, v38, v90, s42 bitop3:0xf6
  v_and_b32 v46, 0xffffff00, v90
  v_bitop3_b32 v39, v39, v91, s43 bitop3:0xf6
  v_and_b32 v47, 0xffffff00, v91
  v_add_f32 v32, v32, v44
  v_add_f32 v33, v33, v45
  v_add_f32 v34, v34, v46
  v_add_f32 v35, v35, v47
  s_waitcnt vmcnt(4)
  v_bitop3_b32 v36, v36, v92, s58 bitop3:0xf6
  v_and_b32 v44, 0xffffff00, v92
  v_bitop3_b32 v37, v37, v93, s39 bitop3:0xf6
  v_and_b32 v45, 0xffffff00, v93
  v_bitop3_b32 v38, v38, v94, s42 bitop3:0xf6
  v_and_b32 v46, 0xffffff00, v94
  v_bitop3_b32 v39, v39, v95, s43 bitop3:0xf6
  v_and_b32 v47, 0xffffff00, v95
  v_add_f32 v32, v32, v44
  v_add_f32 v33, v33, v45
  v_add_f32 v34, v34, v46
  v_add_f32 v35, v35, v47
  s_waitcnt vmcnt(3)
  v_bitop3_b32 v36, v36, v96, s58 bitop3:0xf6
  v_and_b32 v44, 0xffffff00, v96
  v_bitop3_b32 v37, v37, v97, s39 bitop3:0xf6
  v_and_b32 v45, 0xffffff00, v97
  v_bitop3_b32 v38, v38, v98, s42 bitop3:0xf6
  v_and_b32 v46, 0xffffff00, v98
  v_bitop3_b32 v39, v39, v99, s43 bitop3:0xf6
  v_and_b32 v47, 0xffffff00, v99
  v_add_f32 v32, v32, v44
  v_add_f32 v33, v33, v45
  v_add_f32 v34, v34, v46
  v_add_f32 v35, v35, v47
  s_waitcnt vmcnt(2)
  v_bitop3_b32 v36, v36, v100, s58 bitop3:0xf6
  v_and_b32 v44, 0xffffff00, v100
  v_bitop3_b32 v37, v37, v101, s39 bitop3:0xf6
  v_and_b32 v45, 0xffffff00, v101
  v_bitop3_b32 v38, v38, v102, s42 bitop3:0xf6
  v_and_b32 v46, 0xffffff00, v102
  v_bitop3_b32 v39, v39, v103, s43 bitop3:0xf6
  v_and_b32 v47, 0xffffff00, v103
  v_add_f32 v32, v32, v44
  v_add_f32 v33, v33, v45
  v_add_f32 v34, v34, v46
  v_add_f32 v35, v35, v47
  s_waitcnt vmcnt(1)
  v_bitop3_b32 v36, v36, v184, s58 bitop3:0xf6
  v_and_b32 v44, 0xffffff00, v184
  v_bitop3_b32 v37, v37, v185, s39 bitop3:0xf6
  v_and_b32 v45, 0xffffff00, v185
  v_bitop3_b32 v38, v38, v186, s42 bitop3:0xf6
  v_and_b32 v46, 0xffffff00, v186
  v_bitop3_b32 v39, v39, v187, s43 bitop3:0xf6
  v_and_b32 v47, 0xffffff00, v187
  v_add_f32 v32, v32, v44
  v_add_f32 v33, v33, v45
  v_add_f32 v34, v34, v46
  v_add_f32 v35, v35, v47
  s_waitcnt vmcnt(0)
  v_bitop3_b32 v36, v36, v188, s58 bitop3:0xf6
  v_and_b32 v44, 0xffffff00, v188
  v_bitop3_b32 v37, v37, v189, s39 bitop3:0xf6
  v_and_b32 v45, 0xffffff00, v189
  v_bitop3_b32 v38, v38, v190, s42 bitop3:0xf6
  v_and_b32 v46, 0xffffff00, v190
  v_bitop3_b32 v39, v39, v191, s43 bitop3:0xf6
  v_and_b32 v47, 0xffffff00, v191
  v_add_f32 v32, v32, v44
  v_add_f32 v33, v33, v45
  v_add_f32 v34, v34, v46
  v_add_f32 v35, v35, v47
  v_or3_b32 v36, v36, v37, v38
  v_or_b32 v36, v36, v39
  v_and_b32 v36, 0xff, v36
  v_cmp_ne_u32 vcc, 0, v36
  s_sub_u32 s70, s70, 1
  s_cbranch_scc1 L_kvok
  s_cbranch_vccnz L_kvall
L_kvok:
  v_cvt_pk_bf16_f32 v32, v32, v33
  v_cvt_pk_bf16_f32 v33, v34, v35
  ds_write_b64 v41, v[32:33]
  ds_read_b128 v[44:47], v42
  v_add_u32 v20, 0x12000, v8
  s_mov_b32 s4, s44
  ds_read_b32 v22, v24
  s_waitcnt lgkmcnt(0)
  v_cmp_gt_u32 vcc, 10, v22
  s_nop 1
  s_cbranch_vccz L_w11_x
  s_mov_b32 s71, 1048576
L_w11:
  ds_read_b32 v22, v24
  s_sub_u32 s71, s71, 1
  s_waitcnt lgkmcnt(0)
  v_cmp_gt_u32 vcc, 10, v22
  s_cbranch_scc1 L_w11_x
  s_nop 0
  s_cbranch_vccnz L_w11
L_w11_x:
  ds_read_b128 v[212:215], v20 offset:0
  ds_read_b128 v[216:219], v20 offset:4096
  ds_read_b128 v[220:223], v20 offset:8192
  ds_read_b128 v[224:227], v20 offset:12288
  v_mov_b32 v28, v44
  v_mov_b32 v29, v45
  v_mov_b32 v30, v46
  v_mov_b32 v31, v47
  s_waitcnt lgkmcnt(3)
  s_nop 0
  v_mfma_f32_32x32x16_bf16 v[32:47], v[28:31], v[212:215], 0
  s_waitcnt lgkmcnt(2)
  v_mfma_f32_32x32x16_bf16 v[228:243], v[28:31], v[216:219], 0
  s_nop 9
  v_add_f32 v40, 0x358637bd, v40
  v_rcp_f32 v40, v40
  s_nop 0
  v_mul_f32 v32, v32, v40
  v_mul_f32 v33, v33, v40
  v_mul_f32 v34, v34, v40
  v_mul_f32 v35, v35, v40
  v_mul_f32 v36, v36, v40
  v_mul_f32 v37, v37, v40
  v_mul_f32 v38, v38, v40
  v_mul_f32 v39, v39, v40
  v_cvt_pk_bf16_f32 v212, v32, v33
  v_cvt_pk_bf16_f32 v213, v34, v35
  v_cvt_pk_bf16_f32 v214, v36, v37
  v_cvt_pk_bf16_f32 v215, v38, v39
  s_waitcnt lgkmcnt(1)
  v_mfma_f32_32x32x16_bf16 v[32:47], v[28:31], v[220:223], 0
  buffer_store_dwordx4 v[212:215], v27, s[16:19], s4 offen sc1
  s_add_u32 s4, s4, 120832
  v_add_f32 v236, 0x358637bd, v236
  v_rcp_f32 v236, v236
  s_nop 0
  v_mul_f32 v228, v228, v236
  v_mul_f32 v229, v229, v236
  v_mul_f32 v230, v230, v236
  v_mul_f32 v231, v231, v236
  v_mul_f32 v232, v232, v236
  v_mul_f32 v233, v233, v236
  v_mul_f32 v234, v234, v236
  v_mul_f32 v235, v235, v236
  v_cvt_pk_bf16_f32 v216, v228, v229
  v_cvt_pk_bf16_f32 v217, v230, v231
  v_cvt_pk_bf16_f32 v218, v232, v233
  v_cvt_pk_bf16_f32 v219, v234, v235
  s_waitcnt lgkmcnt(0)
  v_mfma_f32_32x32x16_bf16 v[228:243], v[28:31], v[224:227], 0
  buffer_store_dwordx4 v[216:219], v27, s[16:19], s4 offen sc1
  s_add_u32 s4, s4, 120832
  v_add_f32 v40, 0x358637bd, v40
  v_rcp_f32 v40, v40
  s_nop 0
  v_mul_f32 v32, v32, v40
  v_mul_f32 v33, v33, v40
  v_mul_f32 v34, v34, v40
  v_mul_f32 v35, v35, v40
  v_mul_f32 v36, v36, v40
  v_mul_f32 v37, v37, v40
  v_mul_f32 v38, v38, v40
  v_mul_f32 v39, v39, v40
  v_cvt_pk_bf16_f32 v220, v32, v33
  v_cvt_pk_bf16_f32 v221, v34, v35
  v_cvt_pk_bf16_f32 v222, v36, v37
  v_cvt_pk_bf16_f32 v223, v38, v39
  buffer_store_dwordx4 v[220:223], v27, s[16:19], s4 offen sc1
  s_add_u32 s4, s4, 120832
  v_add_f32 v236, 0x358637bd, v236
  v_rcp_f32 v236, v236
  s_nop 0
  v_mul_f32 v228, v228, v236
  v_mul_f32 v229, v229, v236
  v_mul_f32 v230, v230, v236
  v_mul_f32 v231, v231, v236
  v_mul_f32 v232, v232, v236
  v_mul_f32 v233, v233, v236
  v_mul_f32 v234, v234, v236
  v_mul_f32 v235, v235, v236
  v_cvt_pk_bf16_f32 v224, v228, v229
  v_cvt_pk_bf16_f32 v225, v230, v231
  v_cvt_pk_bf16_f32 v226, v232, v233
  v_cvt_pk_bf16_f32 v227, v234, v235
  buffer_store_dwordx4 v[224:227], v27, s[16:19], s4 offen sc1
  s_setprio 1
  ds_write_b128 v9, v[104:107] offset:32768
  ds_write_b128 v9, v[108:111] offset:36864
  ds_write_b128 v9, v[112:115] offset:40960
  ds_write_b128 v9, v[116:119] offset:45056
  ds_write_b128 v9, v[120:123] offset:49152
  ds_write_b128 v9, v[124:127] offset:53248
  ds_write_b128 v9, v[128:131] offset:57344
  ds_write_b128 v9, v[132:135] offset:61440
  ds_write_b128 v10, v[136:139] offset:0
  ds_write_b128 v10, v[140:143] offset:4096
  ds_write_b128 v10, v[144:147] offset:8192
  ds_write_b128 v10, v[148:151] offset:12288
  ds_write_b128 v10, v[152:155] offset:16384
  ds_write_b128 v10, v[156:159] offset:20480
  ds_write_b128 v9, v[160:163] offset:24576
  ds_write_b128 v9, v[164:167] offset:28672
  ds_write_b128 v9, v[168:171] offset:8192
  ds_write_b128 v9, v[172:175] offset:12288
  ds_write_b128 v9, v[176:179] offset:16384
  ds_write_b128 v9, v[180:183] offset:20480
  s_waitcnt lgkmcnt(0)
  v_mov_b32 v26, 4
  s_mov_b64 exec, 1
  ds_write_b32 v11, v26
  s_mov_b64 exec, -1
  s_waitcnt vmcnt(0)
  s_lshl_b32 s68, s60, 5
  s_lshl_b32 s69, s62, 2
  s_add_u32 s68, s68, s69
  s_add_u32 s68, s68, s59
  s_lshl_b32 s68, s68, 2
  s_add_u32 s68, s68, 0xc000
  v_mov_b32 v26, s58
  v_mov_b32 v27, 0
  s_mov_b64 exec, 1
  s_cmp_lg_u32 s46, 0
  s_cbranch_scc1 L_r5
  buffer_store_dword v26, v27, s[16:19], s68 offen
L_r5_x:
  s_mov_b64 exec, -1
  s_add_u32 s68, s48, 196608
  s_cmp_ge_u32 s68, s49
  s_cselect_b32 s69, 360448, 0
  s_sub_u32 s68, s68, s69
  buffer_load_dwordx4 v[48:51], v4, s[20:23], s68 offen
  s_add_u32 s68, s48, 229376
  s_cmp_ge_u32 s68, s49
  s_cselect_b32 s69, 360448, 0
  s_sub_u32 s68, s68, s69
  buffer_load_dwordx4 v[52:55], v4, s[20:23], s68 offen
  s_add_u32 s68, s48, 262144
  s_cmp_ge_u32 s68, s49
  s_cselect_b32 s69, 360448, 0
  s_sub_u32 s68, s68, s69
  buffer_load_dwordx4 v[56:59], v4, s[20:23], s68 offen
  s_add_u32 s68, s48, 294912
  s_cmp_ge_u32 s68, s49
  s_cselect_b32 s69, 360448, 0
  s_sub_u32 s68, s68, s69
  buffer_load_dwordx4 v[60:63], v4, s[20:23], s68 offen
  s_add_u32 s68, s48, 327680
  s_cmp_ge_u32 s68, s49
  s_cselect_b32 s69, 360448, 0
  s_sub_u32 s68, s68, s69
  buffer_load_dwordx4 v[64:67], v4, s[20:23], s68 offen
  s_add_u32 s37, s3, 0
  s_and_b32 s37, s37, 3
  s_lshl_b32 s37, s37, 17
  s_add_u32 s37, s37, s36
  s_add_u32 s68, s37, 0
  buffer_load_dwordx4 v[68:71], v4, s[24:27], s68 offen
  s_add_u32 s68, s37, 32768
  buffer_load_dwordx4 v[72:75], v4, s[24:27], s68 offen
  s_add_u32 s68, s37, 65536
  buffer_load_dwordx4 v[76:79], v4, s[24:27], s68 offen
  s_add_u32 s68, s37, 98304
  buffer_load_dwordx4 v[80:83], v4, s[24:27], s68 offen
  s_waitcnt vmcnt(4)
L_l5:
  ds_read_b32 v28, v24
  s_waitcnt lgkmcnt(0)
  v_cmp_gt_u32 vcc, 11, v28
  s_nop 1
  s_cbranch_vccz L_w12_x
  s_mov_b32 s71, 1048576
L_w12:
  ds_read_b32 v28, v24
  s_sub_u32 s71, s71, 1
  s_waitcnt lgkmcnt(0)
  v_cmp_gt_u32 vcc, 11, v28
  s_cbranch_scc1 L_w12_x
  s_nop 0
  s_cbranch_vccnz L_w12
L_w12_x:
  s_setprio 3
  ds_write_b128 v8, v[48:51] offset:0
  ds_write_b128 v8, v[52:55] offset:4096
  ds_write_b128 v8, v[56:59] offset:8192
  ds_write_b128 v8, v[60:63] offset:12288
  ds_write_b128 v8, v[64:67] offset:16384
  s_waitcnt lgkmcnt(0)
  v_mov_b32 v26, 5
  s_mov_b64 exec, 1
  ds_write_b32 v11, v26
  s_mov_b64 exec, -1
  s_cmp_eq_u32 s63, 0
  s_cbranch_scc0 L_tB
  s_add_u32 s37, s3, 1
  s_and_b32 s37, s37, 3
  s_lshl_b32 s37, s37, 17
  s_add_u32 s37, s37, s36
  s_add_u32 s68, s37, 0
  buffer_load_dwordx4 v[84:87], v4, s[24:27], s68 offen
  s_add_u32 s68, s37, 32768
  buffer_load_dwordx4 v[88:91], v4, s[24:27], s68 offen
  s_add_u32 s68, s37, 65536
  buffer_load_dwordx4 v[92:95], v4, s[24:27], s68 offen
  s_add_u32 s68, s37, 98304
  buffer_load_dwordx4 v[96:99], v4, s[24:27], s68 offen
  s_add_u32 s37, s3, 2
  s_and_b32 s37, s37, 3
  s_lshl_b32 s37, s37, 17
  s_add_u32 s37, s37, s36
  s_add_u32 s68, s37, 0
  buffer_load_dwordx4 v[100:103], v4, s[24:27], s68 offen
  s_add_u32 s68, s37, 32768
  buffer_load_dwordx4 v[184:187], v4, s[24:27], s68 offen
  s_add_u32 s68, s37, 65536
  buffer_load_dwordx4 v[188:191], v4, s[24:27], s68 offen
  s_add_u32 s68, s37, 98304
  buffer_load_dwordx4 v[192:195], v4, s[24:27], s68 offen
  s_add_u32 s37, s3, 3
  s_and_b32 s37, s37, 3
  s_lshl_b32 s37, s37, 17
  s_add_u32 s37, s37, s36
  s_add_u32 s68, s37, 0
  buffer_load_dwordx4 v[196:199], v4, s[24:27], s68 offen
  s_add_u32 s68, s37, 32768
  buffer_load_dwordx4 v[200:203], v4, s[24:27], s68 offen
  s_add_u32 s68, s37, 65536
  buffer_load_dwordx4 v[204:207], v4, s[24:27], s68 offen
  s_add_u32 s68, s37, 98304
  buffer_load_dwordx4 v[208:211], v4, s[24:27], s68 offen
  s_waitcnt vmcnt(15)
  ds_write_b128 v8, v[68:71] offset:24576
  s_waitcnt vmcnt(14)
  ds_write_b128 v8, v[72:75] offset:28672
  s_waitcnt vmcnt(13)
  ds_write_b128 v8, v[76:79] offset:32768
  s_waitcnt vmcnt(12)
  ds_write_b128 v8, v[80:83] offset:36864
  s_waitcnt vmcnt(11)
  ds_write_b128 v8, v[84:87] offset:40960
  s_waitcnt vmcnt(10)
  ds_write_b128 v8, v[88:91] offset:45056
  s_waitcnt vmcnt(9)
  ds_write_b128 v8, v[92:95] offset:49152
  s_waitcnt vmcnt(8)
  ds_write_b128 v8, v[96:99] offset:53248
  s_waitcnt vmcnt(0)
  s_branch L_t2
L_tB:
  s_cmp_lt_u32 s62, 3
  s_cbranch_scc0 L_tB1
  s_add_u32 s37, s3, 1
  s_and_b32 s37, s37, 3
  s_lshl_b32 s37, s37, 17
  s_add_u32 s37, s37, s36
  s_add_u32 s68, s37, 0
  buffer_load_dwordx4 v[84:87], v4, s[24:27], s68 offen
  s_add_u32 s68, s37, 32768
  buffer_load_dwordx4 v[88:91], v4, s[24:27], s68 offen
  s_add_u32 s68, s37, 65536
  buffer_load_dwordx4 v[92:95], v4, s[24:27], s68 offen
  s_add_u32 s68, s37, 98304
  buffer_load_dwordx4 v[96:99], v4, s[24:27], s68 offen
  s_add_u32 s37, s3, 2
  s_and_b32 s37, s37, 3
  s_lshl_b32 s37, s37, 17
  s_add_u32 s37, s37, s36
  s_add_u32 s68, s37, 0
  buffer_load_dwordx4 v[100:103], v4, s[24:27], s68 offen
  s_add_u32 s68, s37, 32768
  buffer_load_dwordx4 v[184:187], v4, s[24:27], s68 offen
  s_add_u32 s68, s37, 65536
  buffer_load_dwordx4 v[188:191], v4, s[24:27], s68 offen
  s_add_u32 s68, s37, 98304
  buffer_load_dwordx4 v[192:195], v4, s[24:27], s68 offen
  s_add_u32 s37, s3, 3
  s_and_b32 s37, s37, 3
  s_lshl_b32 s37, s37, 17
  s_add_u32 s37, s37, s36
  s_add_u32 s68, s37, 0
  buffer_load_dwordx4 v[196:199], v4, s[24:27], s68 offen
  s_add_u32 s68, s37, 32768
  buffer_load_dwordx4 v[200:203], v4, s[24:27], s68 offen
  s_add_u32 s68, s37, 65536
  buffer_load_dwordx4 v[204:207], v4, s[24:27], s68 offen
  s_add_u32 s68, s37, 98304
  buffer_load_dwordx4 v[208:211], v4, s[24:27], s68 offen
  s_waitcnt vmcnt(15)
  ds_write_b128 v8, v[68:71] offset:24576
  s_waitcnt vmcnt(14)
  ds_write_b128 v8, v[72:75] offset:28672
  s_waitcnt vmcnt(13)
  ds_write_b128 v8, v[76:79] offset:32768
  s_waitcnt vmcnt(12)
  ds_write_b128 v8, v[80:83] offset:36864
  s_waitcnt vmcnt(11)
  ds_write_b128 v8, v[84:87] offset:40960
  s_waitcnt vmcnt(10)
  ds_write_b128 v8, v[88:91] offset:45056
  s_waitcnt vmcnt(9)
  ds_write_b128 v8, v[92:95] offset:49152
  s_waitcnt vmcnt(8)
  ds_write_b128 v8, v[96:99] offset:53248
  s_waitcnt vmcnt(0)
  s_branch L_t2
L_tB1:
  s_add_u32 s37, s3, 1
  s_and_b32 s37, s37, 3
  s_lshl_b32 s37, s37, 17
  s_add_u32 s37, s37, s36
  s_add_u32 s68, s37, 0
  buffer_load_dwordx4 v[84:87], v4, s[24:27], s68 offen
  s_add_u32 s68, s37, 32768
  buffer_load_dwordx4 v[88:91], v4, s[24:27], s68 offen
  s_add_u32 s68, s37, 65536
  buffer_load_dwordx4 v[92:95], v4, s[24:27], s68 offen
  s_add_u32 s68, s37, 98304
  buffer_load_dwordx4 v[96:99], v4, s[24:27], s68 offen
  s_add_u32 s37, s3, 2
  s_and_b32 s37, s37, 3
  s_lshl_b32 s37, s37, 17
  s_add_u32 s37, s37, s36
  s_add_u32 s68, s37, 0
  buffer_load_dwordx4 v[100:103], v4, s[24:27], s68 offen
  s_add_u32 s68, s37, 32768
  buffer_load_dwordx4 v[184:187], v4, s[24:27], s68 offen
  s_add_u32 s68, s37, 65536
  buffer_load_dwordx4 v[188:191], v4, s[24:27], s68 offen
  s_add_u32 s68, s37, 98304
  buffer_load_dwordx4 v[192:195], v4, s[24:27], s68 offen
  s_add_u32 s37, s3, 3
  s_and_b32 s37, s37, 3
  s_lshl_b32 s37, s37, 17
  s_add_u32 s37, s37, s36
  s_add_u32 s68, s37, 0
  buffer_load_dwordx4 v[196:199], v4, s[24:27], s68 offen
  s_add_u32 s68, s37, 32768
  buffer_load_dwordx4 v[200:203], v4, s[24:27], s68 offen
  s_add_u32 s68, s37, 65536
  buffer_load_dwordx4 v[204:207], v4, s[24:27], s68 offen
  s_add_u32 s68, s37, 98304
  buffer_load_dwordx4 v[208:211], v4, s[24:27], s68 offen
  s_waitcnt vmcnt(15)
  ds_write_b128 v8, v[68:71] offset:24576
  s_waitcnt vmcnt(14)
  ds_write_b128 v8, v[72:75] offset:28672
  s_waitcnt vmcnt(13)
  ds_write_b128 v8, v[76:79] offset:32768
  s_waitcnt vmcnt(12)
  ds_write_b128 v8, v[80:83] offset:36864
  s_waitcnt vmcnt(11)
  ds_write_b128 v8, v[84:87] offset:40960
  s_waitcnt vmcnt(10)
  ds_write_b128 v8, v[88:91] offset:45056
  s_waitcnt vmcnt(9)
  ds_write_b128 v8, v[92:95] offset:49152
  s_waitcnt vmcnt(8)
  ds_write_b128 v8, v[96:99] offset:53248
  s_waitcnt vmcnt(0)
L_t2:
  s_waitcnt lgkmcnt(0)
  ds_read_b32 v28, v24
  s_waitcnt lgkmcnt(0)
  v_cmp_gt_u32 vcc, 12, v28
  s_nop 1
  s_cbranch_vccz L_w13_x
  s_mov_b32 s71, 1048576
L_w13:
  ds_read_b32 v28, v24
  s_sub_u32 s71, s71, 1
  s_waitcnt lgkmcnt(0)
  v_cmp_gt_u32 vcc, 12, v28
  s_cbranch_scc1 L_w13_x
  s_nop 0
  s_cbranch_vccnz L_w13
L_w13_x:
  ds_write_b128 v8, v[100:103] offset:57344
  ds_write_b128 v8, v[184:187] offset:61440
  ds_write_b128 v9, v[188:191] offset:0
  ds_write_b128 v9, v[192:195] offset:4096
  ds_write_b128 v9, v[196:199] offset:32768
  ds_write_b128 v9, v[200:203] offset:36864
  ds_write_b128 v9, v[204:207] offset:40960
  ds_write_b128 v9, v[208:211] offset:45056
  s_waitcnt lgkmcnt(0)
  v_mov_b32 v26, 6
  s_mov_b64 exec, 1
  ds_write_b32 v11, v26
  s_mov_b64 exec, -1
  s_setprio 1
  v_lshrrev_b32 v26, 3, v0
  v_and_b32 v27, 7, v0
  v_lshlrev_b32 v27, 1, v27
  v_xor_b32 v27, v27, v26
  v_lshlrev_b32 v27, 4, v27
  v_lshl_or_b32 v26, v26, 8, v27
  s_lshl_b32 s68, s59, 12
  s_add_u32 s68, s68, 0x12000
  v_add_u32 v22, s68, v26
  v_xor_b32 v23, 16, v22
  v_add_u32 v24, 0x10000, v22
  v_add_u32 v25, 0x10000, v23
  s_add_u32 s70, s45, 8192
  s_waitcnt lgkmcnt(0)
  v_lshlrev_b32 v48, 16, v244
  v_and_b32 v49, 0xffff0000, v244
  v_lshlrev_b32 v50, 16, v245
  v_and_b32 v51, 0xffff0000, v245
  v_lshlrev_b32 v52, 16, v246
  v_and_b32 v53, 0xffff0000, v246
  v_lshlrev_b32 v54, 16, v247
  v_and_b32 v55, 0xffff0000, v247
  v_lshlrev_b32 v56, 16, v248
  v_and_b32 v57, 0xffff0000, v248
  v_lshlrev_b32 v58, 16, v249
  v_and_b32 v59, 0xffff0000, v249
  v_lshlrev_b32 v60, 16, v250
  v_and_b32 v61, 0xffff0000, v250
  v_lshlrev_b32 v62, 16, v251
  v_and_b32 v63, 0xffff0000, v251
  v_lshlrev_b32 v64, 16, v252
  v_and_b32 v65, 0xffff0000, v252
  v_lshlrev_b32 v66, 16, v253
  v_and_b32 v67, 0xffff0000, v253
  v_lshlrev_b32 v68, 16, v254
  v_and_b32 v69, 0xffff0000, v254
  v_lshlrev_b32 v70, 16, v255
  v_and_b32 v71, 0xffff0000, v255
  s_setprio 1
  s_barrier
  ds_read_b128 v[72:75], v22 offset:40960
  ds_read_b128 v[76:79], v23 offset:40960
  ds_read_b128 v[88:91], v22 offset:57344
  ds_read_b128 v[92:95], v23 offset:57344
  ds_read_b128 v[80:83], v22 offset:43008
  ds_read_b128 v[84:87], v23 offset:43008
  ds_read_b128 v[96:99], v22 offset:59392
  ds_read_b128 v[100:103], v23 offset:59392
  s_waitcnt lgkmcnt(0)
  v_add_f32 v72, v72, v88
  v_add_f32 v73, v73, v89
  v_add_f32 v74, v74, v90
  v_add_f32 v75, v75, v91
  v_add_f32 v76, v76, v92
  v_add_f32 v77, v77, v93
  v_add_f32 v78, v78, v94
  v_add_f32 v79, v79, v95
  v_add_f32 v80, v80, v96
  v_add_f32 v81, v81, v97
  v_add_f32 v82, v82, v98
  v_add_f32 v83, v83, v99
  v_add_f32 v84, v84, v100
  v_add_f32 v85, v85, v101
  v_add_f32 v86, v86, v102
  v_add_f32 v87, v87, v103
  v_add_f32 v72, v72, v64
  v_add_f32 v73, v73, v65
  v_add_f32 v74, v74, v66
  v_add_f32 v75, v75, v67
  v_add_f32 v76, v76, v68
  v_add_f32 v77, v77, v69
  v_add_f32 v78, v78, v70
  v_add_f32 v79, v79, v71
  v_add_f32 v80, v80, v64
  v_add_f32 v81, v81, v65
  v_add_f32 v82, v82, v66
  v_add_f32 v83, v83, v67
  v_add_f32 v84, v84, v68
  v_add_f32 v85, v85, v69
  v_add_f32 v86, v86, v70
  v_add_f32 v87, v87, v71
  v_mul_f32 v32, 0xbfb8aa3b, v72
  v_mul_f32 v33, 0xbfb8aa3b, v73
  v_mul_f32 v34, 0xbfb8aa3b, v74
  v_mul_f32 v35, 0xbfb8aa3b, v75
  v_mul_f32 v36, 0xbfb8aa3b, v76
  v_mul_f32 v37, 0xbfb8aa3b, v77
  v_mul_f32 v38, 0xbfb8aa3b, v78
  v_mul_f32 v39, 0xbfb8aa3b, v79
  v_mul_f32 v40, 0xbfb8aa3b, v80
  v_mul_f32 v41, 0xbfb8aa3b, v81
  v_mul_f32 v42, 0xbfb8aa3b, v82
  v_mul_f32 v43, 0xbfb8aa3b, v83
  v_mul_f32 v44, 0xbfb8aa3b, v84
  v_mul_f32 v45, 0xbfb8aa3b, v85
  v_mul_f32 v46, 0xbfb8aa3b, v86
  v_mul_f32 v47, 0xbfb8aa3b, v87
  v_exp_f32 v32, v32
  v_exp_f32 v33, v33
  v_exp_f32 v34, v34
  v_exp_f32 v35, v35
  v_exp_f32 v36, v36
  v_exp_f32 v37, v37
  v_exp_f32 v38, v38
  v_exp_f32 v39, v39
  v_exp_f32 v40, v40
  v_exp_f32 v41, v41
  v_exp_f32 v42, v42
  v_exp_f32 v43, v43
  v_exp_f32 v44, v44
  v_exp_f32 v45, v45
  v_exp_f32 v46, v46
  v_exp_f32 v47, v47
  v_add_f32 v32, 1.0, v32
  v_add_f32 v33, 1.0, v33
  v_add_f32 v34, 1.0, v34
  v_add_f32 v35, 1.0, v35
  v_add_f32 v36, 1.0, v36
  v_add_f32 v37, 1.0, v37
  v_add_f32 v38, 1.0, v38
  v_add_f32 v39, 1.0, v39
  v_add_f32 v40, 1.0, v40
  v_add_f32 v41, 1.0, v41
  v_add_f32 v42, 1.0, v42
  v_add_f32 v43, 1.0, v43
  v_add_f32 v44, 1.0, v44
  v_add_f32 v45, 1.0, v45
  v_add_f32 v46, 1.0, v46
  v_add_f32 v47, 1.0, v47
  v_rcp_f32 v32, v32
  v_rcp_f32 v33, v33
  v_rcp_f32 v34, v34
  v_rcp_f32 v35, v35
  v_rcp_f32 v36, v36
  v_rcp_f32 v37, v37
  v_rcp_f32 v38, v38
  v_rcp_f32 v39, v39
  v_rcp_f32 v40, v40
  v_rcp_f32 v41, v41
  v_rcp_f32 v42, v42
  v_rcp_f32 v43, v43
  v_rcp_f32 v44, v44
  v_rcp_f32 v45, v45
  v_rcp_f32 v46, v46
  v_rcp_f32 v47, v47
  v_mul_f32 v32, v32, v72
  v_mul_f32 v33, v33, v73
  v_mul_f32 v34, v34, v74
  v_mul_f32 v35, v35, v75
  v_mul_f32 v36, v36, v76
  v_mul_f32 v37, v37, v77
  v_mul_f32 v38, v38, v78
  v_mul_f32 v39, v39, v79
  v_mul_f32 v40, v40, v80
  v_mul_f32 v41, v41, v81
  v_mul_f32 v42, v42, v82
  v_mul_f32 v43, v43, v83
  v_mul_f32 v44, v44, v84
  v_mul_f32 v45, v45, v85
  v_mul_f32 v46, v46, v86
  v_mul_f32 v47, v47, v87
  s_barrier
  ds_read_b128 v[72:75], v22 offset:0
  ds_read_b128 v[76:79], v23 offset:0
  ds_read_b128 v[88:91], v24 offset:8192
  ds_read_b128 v[92:95], v25 offset:8192
  ds_read_b128 v[80:83], v22 offset:2048
  ds_read_b128 v[84:87], v23 offset:2048
  ds_read_b128 v[96:99], v24 offset:10240
  ds_read_b128 v[100:103], v25 offset:10240
  s_waitcnt lgkmcnt(4)
  v_pk_add_f32 v[72:73], v[72:73], v[88:89]
  v_pk_add_f32 v[74:75], v[74:75], v[90:91]
  v_pk_add_f32 v[76:77], v[76:77], v[92:93]
  v_pk_add_f32 v[78:79], v[78:79], v[94:95]
  v_pk_fma_f32 v[72:73], v[72:73], v[32:33], v[48:49]
  v_pk_fma_f32 v[74:75], v[74:75], v[34:35], v[50:51]
  v_pk_fma_f32 v[76:77], v[76:77], v[36:37], v[52:53]
  v_pk_fma_f32 v[78:79], v[78:79], v[38:39], v[54:55]
  v_cvt_pk_bf16_f32 v64, v72, v73
  v_cvt_pk_bf16_f32 v65, v74, v75
  v_cvt_pk_bf16_f32 v66, v76, v77
  v_cvt_pk_bf16_f32 v67, v78, v79
  buffer_store_dwordx4 v[64:67], v19, s[12:15], s45 offen sc1
  s_waitcnt lgkmcnt(0)
  v_pk_add_f32 v[80:81], v[80:81], v[96:97]
  v_pk_add_f32 v[82:83], v[82:83], v[98:99]
  v_pk_add_f32 v[84:85], v[84:85], v[100:101]
  v_pk_add_f32 v[86:87], v[86:87], v[102:103]
  v_pk_fma_f32 v[80:81], v[80:81], v[40:41], v[56:57]
  v_pk_fma_f32 v[82:83], v[82:83], v[42:43], v[58:59]
  v_pk_fma_f32 v[84:85], v[84:85], v[44:45], v[60:61]
  v_pk_fma_f32 v[86:87], v[86:87], v[46:47], v[62:63]
  v_cvt_pk_bf16_f32 v68, v80, v81
  v_cvt_pk_bf16_f32 v69, v82, v83
  v_cvt_pk_bf16_f32 v70, v84, v85
  v_cvt_pk_bf16_f32 v71, v86, v87
  buffer_store_dwordx4 v[68:71], v19, s[12:15], s70 offen sc1
L_end:
  s_endpgm
L_r1:
  buffer_store_dword v26, v27, s[16:19], s6 offen sc1
  s_branch L_r1_x
L_r2:
  buffer_store_dword v26, v27, s[16:19], s6 offen sc1
  s_branch L_r2_x
L_r3:
  buffer_store_dword v26, v27, s[16:19], s6 offen sc1
  s_branch L_r3_x
L_r4:
  buffer_store_dword v26, v27, s[16:19], s6 offen sc1
  s_branch L_r4_x
L_r5:
  buffer_store_dword v26, v27, s[16:19], s68 offen sc1
  s_branch L_r5_x
L_compute:
  s_setprio 3
  s_lshl_b32 s68, s60, 4
  s_add_u32 s68, s68, s61
  s_lshl_b32 s68, s68, 2
  s_add_u32 s68, s68, s59
  s_lshl_b32 s68, s68, 1
  s_lshl_b32 s69, s68, 10
  v_lshrrev_b32 v26, 5, v0
  v_and_b32 v27, 31, v0
  v_lshlrev_b32 v28, 4, v27
  v_lshl_or_b32 v28, v26, 10, v28
  s_waitcnt lgkmcnt(0)
  s_mov_b32 s4, s36
  s_mov_b32 s5, s37
  s_mov_b32 s6, 0x200000
  s_mov_b32 s7, 0x20000
  s_load_dword s58, s[56:57], 0
  buffer_load_dwordx4 v[32:35], v28, s[4:7], s69 offen
  buffer_load_dwordx4 v[36:39], v28, s[4:7], s69 offen offset:512
  s_mov_b32 s16, s56
  s_mov_b32 s17, s57
  s_mov_b32 s18, 0xa00000
  s_mov_b32 s19, 0x20000
  s_lshr_b32 s71, s2, 6
  s_and_b32 s65, s2, 7
  s_lshl_b32 s65, s65, 2
  s_add_u32 s65, s65, s71
  s_bfe_u32 s66, s2, 0x30003
  s_lshl_b32 s67, s71, 1
  s_add_u32 s67, s67, s66
  s_and_b32 s67, s67, 7
  s_add_u32 s3, s71, s66
  s_mul_i32 s47, s71, 3
  s_and_b32 s71, s66, 1
  s_add_u32 s47, s47, s71
  v_lshlrev_b32 v1, 4, v0
  v_lshrrev_b32 v29, 5, v0
  v_bfe_u32 v30, v0, 2, 2
  v_lshl_add_u32 v29, v29, 3, v30
  v_lshlrev_b32 v20, 7, v29
  v_bfe_u32 v29, v0, 3, 1
  v_lshl_or_b32 v20, v29, 6, v20
  v_bfe_u32 v29, v0, 4, 1
  v_lshl_or_b32 v20, v29, 5, v20
  v_and_b32 v29, 3, v0
  v_lshl_or_b32 v20, v29, 3, v20
  v_xor_b32 v21, 64, v20
  v_add_u32 v22, 0x10000, v20
  v_add_u32 v23, 0x10000, v21
  v_add_u32 v24, 0x16000, v20
  v_add_u32 v25, 0x16000, v21
  v_bfe_u32 v29, v0, 1, 3
  v_xor_b32 v29, v29, v26
  v_lshlrev_b32 v29, 4, v29
  v_lshl_or_b32 v29, v27, 7, v29
  s_lshl_b32 s70, s59, 12
  v_add_u32 v12, s70, v29
  v_xor_b32 v13, 32, v12
  v_xor_b32 v14, 64, v12
  v_xor_b32 v15, 96, v12
  v_add_u32 v16, 0x10000, v12
  v_add_u32 v17, 0x10000, v13
  v_add_u32 v18, 0x10000, v14
  v_add_u32 v19, 0x10000, v15
  s_lshl_b32 s76, s60, 2
  s_add_u32 s76, s76, s59
  s_lshl_b32 s76, s76, 8
  s_add_u32 s76, s76, 0x1000
  s_lshl_b32 s79, s61, 1
  s_lshr_b32 s70, s60, 3
  s_add_u32 s79, s79, s70
  s_lshl_b32 s79, s79, 2
  s_add_u32 s79, s79, s59
  s_lshl_b32 s79, s79, 3
  s_and_b32 s70, s60, 7
  s_add_u32 s79, s79, s70
  s_lshl_b32 s79, s79, 9
  s_add_u32 s79, s79, 0xa0000
  s_lshr_b32 s53, s59, 1
  s_lshl_b32 s72, s53, 12
  s_mov_b32 s55, 0
  s_lshl_b32 s71, s65, 1
  s_and_b32 s70, s59, 1
  s_add_u32 s71, s71, s70
  s_mul_i32 s77, s71, 120832
  s_add_u32 s77, s77, 0x140000
  s_lshl_b32 s51, s71, 7
  s_add_u32 s54, s51, 0xa000
  s_add_u32 s44, s51, 0xe000
  s_add_u32 s51, s51, 0x8000
  s_lshr_b32 s52, s65, 1
  s_lshl_b32 s52, s52, 7
  s_add_u32 s52, s52, 0xc000
  s_lshl_b32 s73, s70, 13
  s_lshl_b32 s71, s53, 14
  s_add_u32 s73, s73, s71
  s_add_u32 s73, s73, 0x1c000
  s_cmp_eq_u32 s53, 0
  s_mov_b32 s15, 0x4000
  s_cmov_b32 s15, 0xffff6000
  s_mov_b32 s14, s47
  s_add_u32 s36, s67, 0
  s_and_b32 s36, s36, 7
  s_lshl_b32 s36, s36, 13
  s_add_u32 s36, s36, s77
  s_add_u32 s37, s67, 1
  s_and_b32 s37, s37, 7
  s_lshl_b32 s37, s37, 13
  s_add_u32 s37, s37, s77
  s_add_u32 s38, s67, 2
  s_and_b32 s38, s38, 7
  s_lshl_b32 s38, s38, 13
  s_add_u32 s38, s38, s77
  s_add_u32 s39, s67, 3
  s_and_b32 s39, s39, 7
  s_lshl_b32 s39, s39, 13
  s_add_u32 s39, s39, s77
  s_add_u32 s40, s67, 4
  s_and_b32 s40, s40, 7
  s_lshl_b32 s40, s40, 13
  s_add_u32 s40, s40, s77
  s_add_u32 s41, s67, 5
  s_and_b32 s41, s41, 7
  s_lshl_b32 s41, s41, 13
  s_add_u32 s41, s41, s77
  s_add_u32 s42, s67, 6
  s_and_b32 s42, s42, 7
  s_lshl_b32 s42, s42, 13
  s_add_u32 s42, s42, s77
  s_add_u32 s43, s67, 7
  s_and_b32 s43, s43, 7
  s_lshl_b32 s43, s43, 13
  s_add_u32 s43, s43, s77
  s_add_u32 s47, s3, 0
  s_and_b32 s47, s47, 3
  s_lshl_b32 s47, s47, 13
  s_add_u32 s47, s47, s77
  s_add_u32 s47, s47, 88064
  s_add_u32 s48, s3, 1
  s_and_b32 s48, s48, 3
  s_lshl_b32 s48, s48, 13
  s_add_u32 s48, s48, s77
  s_add_u32 s48, s48, 88064
  s_add_u32 s49, s3, 2
  s_and_b32 s49, s49, 3
  s_lshl_b32 s49, s49, 13
  s_add_u32 s49, s49, s77
  s_add_u32 s49, s49, 88064
  s_add_u32 s50, s3, 3
  s_and_b32 s50, s50, 3
  s_lshl_b32 s50, s50, 13
  s_add_u32 s50, s50, s77
  s_add_u32 s50, s50, 88064
  s_add_u32 s14, s14, s53
  s_add_u32 s8, s14, 0
  s_cmp_ge_u32 s8, 11
  s_cselect_b32 s71, 11, 0
  s_sub_u32 s8, s8, s71
  s_sub_u32 s8, s8, s53
  s_add_u32 s8, s8, 32
  s_lshl_b32 s8, s8, 11
  s_add_u32 s8, s8, s77
  s_add_u32 s9, s14, 2
  s_cmp_ge_u32 s9, 11
  s_cselect_b32 s71, 11, 0
  s_sub_u32 s9, s9, s71
  s_sub_u32 s9, s9, s53
  s_add_u32 s9, s9, 30
  s_lshl_b32 s9, s9, 11
  s_add_u32 s9, s9, s77
  s_add_u32 s10, s14, 4
  s_cmp_ge_u32 s10, 11
  s_cselect_b32 s71, 11, 0
  s_sub_u32 s10, s10, s71
  s_sub_u32 s10, s10, s53
  s_add_u32 s10, s10, 32
  s_lshl_b32 s10, s10, 11
  s_add_u32 s10, s10, s77
  s_add_u32 s11, s14, 6
  s_cmp_ge_u32 s11, 11
  s_cselect_b32 s71, 11, 0
  s_sub_u32 s11, s11, s71
  s_sub_u32 s11, s11, s53
  s_add_u32 s11, s11, 30
  s_lshl_b32 s11, s11, 11
  s_add_u32 s11, s11, s77
  s_add_u32 s12, s14, 8
  s_cmp_ge_u32 s12, 11
  s_cselect_b32 s71, 11, 0
  s_sub_u32 s12, s12, s71
  s_sub_u32 s12, s12, s53
  s_add_u32 s12, s12, 32
  s_lshl_b32 s12, s12, 11
  s_add_u32 s12, s12, s77
  s_add_u32 s13, s14, 10
  s_cmp_ge_u32 s13, 11
  s_cselect_b32 s71, 11, 0
  s_sub_u32 s13, s13, s71
  s_sub_u32 s13, s13, s53
  s_add_u32 s13, s13, 30
  s_lshl_b32 s13, s13, 11
  s_add_u32 s13, s13, s77
  s_mov_b32 s74, 0x358637bd
  s_mov_b32 s75, 0x358637bd
  s_mov_b32 s70, 0x3f803f80
  v_mov_b32 v40, 0
  v_mov_b32 v41, 0
  v_mov_b32 v42, 0
  v_mov_b32 v43, 0
  s_waitcnt vmcnt(0)
  v_dot2_f32_bf16 v40, v32, s70, v40
  v_dot2_f32_bf16 v42, v32, v32, v42
  v_dot2_f32_bf16 v41, v33, s70, v41
  v_dot2_f32_bf16 v43, v33, v33, v43
  v_dot2_f32_bf16 v40, v34, s70, v40
  v_dot2_f32_bf16 v42, v34, v34, v42
  v_dot2_f32_bf16 v41, v35, s70, v41
  v_dot2_f32_bf16 v43, v35, v35, v43
  v_dot2_f32_bf16 v40, v36, s70, v40
  v_dot2_f32_bf16 v42, v36, v36, v42
  v_dot2_f32_bf16 v41, v37, s70, v41
  v_dot2_f32_bf16 v43, v37, v37, v43
  v_dot2_f32_bf16 v40, v38, s70, v40
  v_dot2_f32_bf16 v42, v38, v38, v42
  v_dot2_f32_bf16 v41, v39, s70, v41
  v_dot2_f32_bf16 v43, v39, v39, v43
  s_nop 2
  v_add_f32 v40, v40, v41
  v_add_f32 v42, v42, v43
  s_nop 0
  v_add_f32_dpp v40, v40, v40 row_ror:8 row_mask:0xf bank_mask:0xf
  v_add_f32_dpp v42, v42, v42 row_ror:8 row_mask:0xf bank_mask:0xf
  s_nop 0
  v_add_f32_dpp v40, v40, v40 row_ror:4 row_mask:0xf bank_mask:0xf
  v_add_f32_dpp v42, v42, v42 row_ror:4 row_mask:0xf bank_mask:0xf
  s_nop 0
  v_add_f32_dpp v40, v40, v40 row_ror:2 row_mask:0xf bank_mask:0xf
  v_add_f32_dpp v42, v42, v42 row_ror:2 row_mask:0xf bank_mask:0xf
  s_nop 0
  v_add_f32_dpp v40, v40, v40 row_ror:1 row_mask:0xf bank_mask:0xf
  v_add_f32_dpp v42, v42, v42 row_ror:1 row_mask:0xf bank_mask:0xf
  v_mov_b32 v41, v40
  v_mov_b32 v43, v42
  s_nop 0
  v_permlane16_swap_b32 v40, v41
  v_permlane16_swap_b32 v42, v43
  v_add_f32 v40, v40, v41
  v_add_f32 v42, v42, v43
  v_mul_f32 v40, 0x3b000000, v40
  v_mul_f32 v42, 0x3b000000, v42
  v_fma_f32 v42, -v40, v40, v42
  v_max_f32 v42, 0, v42
  v_cvt_pk_bf16_f32 v42, v42, v42
  v_and_b32 v42, 0xffff0000, v42
  v_add_f32 v42, 0x3727c5ac, v42
  v_cvt_pk_bf16_f32 v42, v42, v42
  v_and_b32 v42, 0xffff0000, v42
  v_sqrt_f32 v42, v42
  s_nop 0
  v_cvt_pk_bf16_f32 v44, v40, v42
  v_lshlrev_b32 v28, 3, v26
  s_lshl_b32 s68, s68, 3
  s_add_u32 s68, s68, 0x1000
  s_waitcnt lgkmcnt(0)
  s_add_u32 s58, s58, 1
  s_getreg_b32 s78, hwreg(HW_REG_XCC_ID, 0, 4)
  s_lshl_b32 s78, s78, 28
  s_xor_b32 s78, s78, s58
  v_mov_b32 v45, s78
  v_mov_b32 v5, s58
  s_mov_b32 s56, s68
  v_mov_b32 v2, v44
  v_mov_b32 v3, v45
  v_mov_b32 v25, v28
  v_lshlrev_b32 v26, 3, v27
  v_lshlrev_b32 v27, 3, v0
  s_lshl_b32 s68, s59, 8
  s_add_u32 s68, s68, 0x27000
  v_lshl_add_u32 v28, v0, 2, s68
  v_add_u32 v29, 0x26000, v27
  s_lshl_b32 s68, s59, 2
  s_add_u32 s68, s68, 0x26810
  v_mov_b32 v30, s68
  v_and_b32 v31, 3, v0
  v_lshlrev_b32 v31, 2, v31
  v_add_u32 v31, 0x26800, v31
  s_barrier
  ds_read_b128 v[128:131], v12 offset:0
  ds_read_b64_tr_b16 v[32:33], v20 offset:16384
  ds_read_b64_tr_b16 v[34:35], v20 offset:16896
  ds_read_b64_tr_b16 v[36:37], v21 offset:16384
  ds_read_b64_tr_b16 v[38:39], v21 offset:16896
  ds_read_b64_tr_b16 v[40:41], v20 offset:24576
  ds_read_b64_tr_b16 v[42:43], v20 offset:25088
  ds_read_b64_tr_b16 v[44:45], v21 offset:24576
  ds_read_b64_tr_b16 v[46:47], v21 offset:25088
  s_mov_b32 exec_lo, 1
  s_mov_b32 exec_hi, 1
  buffer_store_dwordx2 v[2:3], v25, s[16:19], s56 offen sc1
  s_mov_b64 exec, -1
  v_add_u32 v25, 0x16000, v21
  s_waitcnt lgkmcnt(6)
  v_mfma_f32_32x32x16_bf16 v[64:79], v[32:35], v[128:131], 0
  ds_read_b128 v[132:135], v13 offset:0
  ds_read_b64_tr_b16 v[48:49], v20 offset:18432
  ds_read_b64_tr_b16 v[50:51], v20 offset:18944
  s_waitcnt lgkmcnt(7)
  v_mfma_f32_32x32x16_bf16 v[80:95], v[36:39], v[128:131], 0
  ds_read_b64_tr_b16 v[52:53], v21 offset:18432
  ds_read_b64_tr_b16 v[54:55], v21 offset:18944
  s_waitcnt lgkmcnt(7)
  v_mfma_f32_32x32x16_bf16 v[96:111], v[40:43], v[128:131], 0
  ds_read_b64_tr_b16 v[56:57], v20 offset:26624
  ds_read_b64_tr_b16 v[58:59], v20 offset:27136
  s_waitcnt lgkmcnt(7)
  v_mfma_f32_32x32x16_bf16 v[112:127], v[44:47], v[128:131], 0
  ds_read_b64_tr_b16 v[60:61], v21 offset:26624
  ds_read_b64_tr_b16 v[62:63], v21 offset:27136
  s_waitcnt lgkmcnt(6)
  v_mfma_f32_32x32x16_bf16 v[64:79], v[48:51], v[132:135], v[64:79]
  ds_read_b128 v[136:139], v14 offset:0
  ds_read_b64_tr_b16 v[32:33], v20 offset:20480
  ds_read_b64_tr_b16 v[34:35], v20 offset:20992
  s_waitcnt lgkmcnt(7)
  v_mfma_f32_32x32x16_bf16 v[80:95], v[52:55], v[132:135], v[80:95]
  ds_read_b64_tr_b16 v[36:37], v21 offset:20480
  ds_read_b64_tr_b16 v[38:39], v21 offset:20992
  s_waitcnt lgkmcnt(7)
  v_mfma_f32_32x32x16_bf16 v[96:111], v[56:59], v[132:135], v[96:111]
  ds_read_b64_tr_b16 v[40:41], v20 offset:28672
  ds_read_b64_tr_b16 v[42:43], v20 offset:29184
  s_waitcnt lgkmcnt(7)
  v_mfma_f32_32x32x16_bf16 v[112:127], v[60:63], v[132:135], v[112:127]
  ds_read_b64_tr_b16 v[44:45], v21 offset:28672
  ds_read_b64_tr_b16 v[46:47], v21 offset:29184
  s_waitcnt lgkmcnt(6)
  v_mfma_f32_32x32x16_bf16 v[64:79], v[32:35], v[136:139], v[64:79]
  ds_read_b128 v[140:143], v15 offset:0
  ds_read_b64_tr_b16 v[48:49], v20 offset:22528
  ds_read_b64_tr_b16 v[50:51], v20 offset:23040
  s_waitcnt lgkmcnt(7)
  v_mfma_f32_32x32x16_bf16 v[80:95], v[36:39], v[136:139], v[80:95]
  ds_read_b64_tr_b16 v[52:53], v21 offset:22528
  ds_read_b64_tr_b16 v[54:55], v21 offset:23040
  s_waitcnt lgkmcnt(7)
  v_mfma_f32_32x32x16_bf16 v[96:111], v[40:43], v[136:139], v[96:111]
  ds_read_b64_tr_b16 v[56:57], v20 offset:30720
  ds_read_b64_tr_b16 v[58:59], v20 offset:31232
  s_waitcnt lgkmcnt(7)
  v_mfma_f32_32x32x16_bf16 v[112:127], v[44:47], v[136:139], v[112:127]
  ds_read_b64_tr_b16 v[60:61], v21 offset:30720
  ds_read_b64_tr_b16 v[62:63], v21 offset:31232
  s_waitcnt lgkmcnt(6)
  v_mfma_f32_32x32x16_bf16 v[64:79], v[48:51], v[140:143], v[64:79]
  s_waitcnt lgkmcnt(4)
  v_mfma_f32_32x32x16_bf16 v[80:95], v[52:55], v[140:143], v[80:95]
  s_waitcnt lgkmcnt(0)
  s_barrier
  ds_read_b128 v[144:147], v12 offset:32768
  ds_read_b64_tr_b16 v[32:33], v20 offset:49152
  ds_read_b64_tr_b16 v[34:35], v20 offset:49664
  ds_read_b64_tr_b16 v[36:37], v21 offset:49152
  ds_read_b64_tr_b16 v[38:39], v21 offset:49664
  v_mfma_f32_32x32x16_bf16 v[96:111], v[56:59], v[140:143], v[96:111]
  ds_read_b64_tr_b16 v[40:41], v20 offset:57344
  ds_read_b64_tr_b16 v[42:43], v20 offset:57856
  ds_read_b64_tr_b16 v[44:45], v21 offset:57344
  ds_read_b64_tr_b16 v[46:47], v21 offset:57856
  v_mfma_f32_32x32x16_bf16 v[112:127], v[60:63], v[140:143], v[112:127]
  s_waitcnt lgkmcnt(6)
  v_mfma_f32_32x32x16_bf16 v[64:79], v[32:35], v[144:147], v[64:79]
  ds_read_b128 v[148:151], v13 offset:32768
  ds_read_b64_tr_b16 v[48:49], v20 offset:51200
  ds_read_b64_tr_b16 v[50:51], v20 offset:51712
  s_waitcnt lgkmcnt(7)
  v_mfma_f32_32x32x16_bf16 v[80:95], v[36:39], v[144:147], v[80:95]
  ds_read_b64_tr_b16 v[52:53], v21 offset:51200
  ds_read_b64_tr_b16 v[54:55], v21 offset:51712
  s_waitcnt lgkmcnt(7)
  v_mfma_f32_32x32x16_bf16 v[96:111], v[40:43], v[144:147], v[96:111]
  ds_read_b64_tr_b16 v[56:57], v20 offset:59392
  ds_read_b64_tr_b16 v[58:59], v20 offset:59904
  s_waitcnt lgkmcnt(7)
  v_mfma_f32_32x32x16_bf16 v[112:127], v[44:47], v[144:147], v[112:127]
  ds_read_b64_tr_b16 v[60:61], v21 offset:59392
  ds_read_b64_tr_b16 v[62:63], v21 offset:59904
  s_waitcnt lgkmcnt(6)
  v_mfma_f32_32x32x16_bf16 v[64:79], v[48:51], v[148:151], v[64:79]
  ds_read_b128 v[152:155], v14 offset:32768
  ds_read_b64_tr_b16 v[32:33], v20 offset:53248
  ds_read_b64_tr_b16 v[34:35], v20 offset:53760
  s_waitcnt lgkmcnt(7)
  v_mfma_f32_32x32x16_bf16 v[80:95], v[52:55], v[148:151], v[80:95]
  ds_read_b64_tr_b16 v[36:37], v21 offset:53248
  ds_read_b64_tr_b16 v[38:39], v21 offset:53760
  s_waitcnt lgkmcnt(7)
  v_mfma_f32_32x32x16_bf16 v[96:111], v[56:59], v[148:151], v[96:111]
  ds_read_b64_tr_b16 v[40:41], v20 offset:61440
  ds_read_b64_tr_b16 v[42:43], v20 offset:61952
  s_waitcnt lgkmcnt(7)
  v_mfma_f32_32x32x16_bf16 v[112:127], v[60:63], v[148:151], v[112:127]
  ds_read_b64_tr_b16 v[44:45], v21 offset:61440
  ds_read_b64_tr_b16 v[46:47], v21 offset:61952
  s_waitcnt lgkmcnt(6)
  v_mfma_f32_32x32x16_bf16 v[64:79], v[32:35], v[152:155], v[64:79]
  ds_read_b128 v[156:159], v15 offset:32768
  ds_read_b64_tr_b16 v[48:49], v20 offset:55296
  ds_read_b64_tr_b16 v[50:51], v20 offset:55808
  s_waitcnt lgkmcnt(7)
  v_mfma_f32_32x32x16_bf16 v[80:95], v[36:39], v[152:155], v[80:95]
  ds_read_b64_tr_b16 v[52:53], v21 offset:55296
  ds_read_b64_tr_b16 v[54:55], v21 offset:55808
  s_waitcnt lgkmcnt(7)
  v_mfma_f32_32x32x16_bf16 v[96:111], v[40:43], v[152:155], v[96:111]
  ds_read_b64_tr_b16 v[56:57], v20 offset:63488
  ds_read_b64_tr_b16 v[58:59], v20 offset:64000
  s_waitcnt lgkmcnt(7)
  v_mfma_f32_32x32x16_bf16 v[112:127], v[44:47], v[152:155], v[112:127]
  ds_read_b64_tr_b16 v[60:61], v21 offset:63488
  ds_read_b64_tr_b16 v[62:63], v21 offset:64000
  s_waitcnt lgkmcnt(6)
  v_mfma_f32_32x32x16_bf16 v[64:79], v[48:51], v[156:159], v[64:79]
  s_waitcnt lgkmcnt(4)
  v_mfma_f32_32x32x16_bf16 v[80:95], v[52:55], v[156:159], v[80:95]
  s_waitcnt lgkmcnt(0)
  s_barrier
  ds_read_b128 v[160:163], v16 offset:0
  ds_read_b64_tr_b16 v[32:33], v22 offset:16384
  ds_read_b64_tr_b16 v[34:35], v22 offset:16896
  ds_read_b64_tr_b16 v[36:37], v23 offset:16384
  ds_read_b64_tr_b16 v[38:39], v23 offset:16896
  v_mfma_f32_32x32x16_bf16 v[96:111], v[56:59], v[156:159], v[96:111]
  ds_read_b64_tr_b16 v[40:41], v22 offset:24576
  ds_read_b64_tr_b16 v[42:43], v22 offset:25088
  ds_read_b64_tr_b16 v[44:45], v23 offset:24576
  ds_read_b64_tr_b16 v[46:47], v23 offset:25088
  v_mfma_f32_32x32x16_bf16 v[112:127], v[60:63], v[156:159], v[112:127]
  s_waitcnt lgkmcnt(6)
  v_mfma_f32_32x32x16_bf16 v[64:79], v[32:35], v[160:163], v[64:79]
  ds_read_b128 v[164:167], v17 offset:0
  ds_read_b64_tr_b16 v[48:49], v22 offset:18432
  ds_read_b64_tr_b16 v[50:51], v22 offset:18944
  s_waitcnt lgkmcnt(7)
  v_mfma_f32_32x32x16_bf16 v[80:95], v[36:39], v[160:163], v[80:95]
  ds_read_b64_tr_b16 v[52:53], v23 offset:18432
  ds_read_b64_tr_b16 v[54:55], v23 offset:18944
  s_waitcnt lgkmcnt(7)
  v_mfma_f32_32x32x16_bf16 v[96:111], v[40:43], v[160:163], v[96:111]
  ds_read_b64_tr_b16 v[56:57], v22 offset:26624
  ds_read_b64_tr_b16 v[58:59], v22 offset:27136
  s_waitcnt lgkmcnt(7)
  v_mfma_f32_32x32x16_bf16 v[112:127], v[44:47], v[160:163], v[112:127]
  ds_read_b64_tr_b16 v[60:61], v23 offset:26624
  ds_read_b64_tr_b16 v[62:63], v23 offset:27136
  s_waitcnt lgkmcnt(6)
  v_mfma_f32_32x32x16_bf16 v[64:79], v[48:51], v[164:167], v[64:79]
  ds_read_b128 v[168:171], v18 offset:0
  ds_read_b64_tr_b16 v[32:33], v22 offset:20480
  ds_read_b64_tr_b16 v[34:35], v22 offset:20992
  s_waitcnt lgkmcnt(7)
  v_mfma_f32_32x32x16_bf16 v[80:95], v[52:55], v[164:167], v[80:95]
  ds_read_b64_tr_b16 v[36:37], v23 offset:20480
  ds_read_b64_tr_b16 v[38:39], v23 offset:20992
  s_waitcnt lgkmcnt(7)
  v_mfma_f32_32x32x16_bf16 v[96:111], v[56:59], v[164:167], v[96:111]
  ds_read_b64_tr_b16 v[40:41], v22 offset:28672
  ds_read_b64_tr_b16 v[42:43], v22 offset:29184
  s_waitcnt lgkmcnt(7)
  v_mfma_f32_32x32x16_bf16 v[112:127], v[60:63], v[164:167], v[112:127]
  ds_read_b64_tr_b16 v[44:45], v23 offset:28672
  ds_read_b64_tr_b16 v[46:47], v23 offset:29184
  s_waitcnt lgkmcnt(6)
  v_mfma_f32_32x32x16_bf16 v[64:79], v[32:35], v[168:171], v[64:79]
  ds_read_b128 v[172:175], v19 offset:0
  ds_read_b64_tr_b16 v[48:49], v22 offset:22528
  ds_read_b64_tr_b16 v[50:51], v22 offset:23040
  s_waitcnt lgkmcnt(7)
  v_mfma_f32_32x32x16_bf16 v[80:95], v[36:39], v[168:171], v[80:95]
  ds_read_b64_tr_b16 v[52:53], v23 offset:22528
  ds_read_b64_tr_b16 v[54:55], v23 offset:23040
  s_waitcnt lgkmcnt(7)
  v_mfma_f32_32x32x16_bf16 v[96:111], v[40:43], v[168:171], v[96:111]
  ds_read_b64_tr_b16 v[56:57], v22 offset:30720
  ds_read_b64_tr_b16 v[58:59], v22 offset:31232
  s_waitcnt lgkmcnt(7)
  v_mfma_f32_32x32x16_bf16 v[112:127], v[44:47], v[168:171], v[112:127]
  ds_read_b64_tr_b16 v[60:61], v23 offset:30720
  ds_read_b64_tr_b16 v[62:63], v23 offset:31232
  s_waitcnt lgkmcnt(6)
  v_mfma_f32_32x32x16_bf16 v[64:79], v[48:51], v[172:175], v[64:79]
  ds_read_b32 v4, v28
  s_waitcnt lgkmcnt(5)
  v_mfma_f32_32x32x16_bf16 v[80:95], v[52:55], v[172:175], v[80:95]
  s_waitcnt lgkmcnt(0)
  s_barrier
  ds_read_b128 v[176:179], v12 offset:0
  ds_read_b64_tr_b16 v[32:33], v20 offset:16384
  ds_read_b64_tr_b16 v[34:35], v20 offset:16896
  ds_read_b64_tr_b16 v[36:37], v21 offset:16384
  ds_read_b64_tr_b16 v[38:39], v21 offset:16896
  v_mfma_f32_32x32x16_bf16 v[96:111], v[56:59], v[172:175], v[96:111]
  buffer_store_dwordx2 v[4:5], v27, s[16:19], s79 offen sc1
  ds_read_b64_tr_b16 v[40:41], v20 offset:24576
  ds_read_b64_tr_b16 v[42:43], v20 offset:25088
  ds_read_b64_tr_b16 v[44:45], v21 offset:24576
  ds_read_b64_tr_b16 v[46:47], v21 offset:25088
  v_mfma_f32_32x32x16_bf16 v[112:127], v[60:63], v[172:175], v[112:127]
  s_waitcnt lgkmcnt(6)
  v_mfma_f32_32x32x16_bf16 v[64:79], v[32:35], v[176:179], v[64:79]
  ds_read_b128 v[180:183], v13 offset:0
  ds_read_b64_tr_b16 v[48:49], v20 offset:18432
  ds_read_b64_tr_b16 v[50:51], v20 offset:18944
  s_waitcnt lgkmcnt(7)
  v_mfma_f32_32x32x16_bf16 v[80:95], v[36:39], v[176:179], v[80:95]
  ds_read_b64_tr_b16 v[52:53], v21 offset:18432
  ds_read_b64_tr_b16 v[54:55], v21 offset:18944
  s_waitcnt lgkmcnt(7)
  v_mfma_f32_32x32x16_bf16 v[96:111], v[40:43], v[176:179], v[96:111]
  ds_read_b64_tr_b16 v[56:57], v20 offset:26624
  ds_read_b64_tr_b16 v[58:59], v20 offset:27136
  s_waitcnt lgkmcnt(7)
  v_mfma_f32_32x32x16_bf16 v[112:127], v[44:47], v[176:179], v[112:127]
  ds_read_b64_tr_b16 v[60:61], v21 offset:26624
  ds_read_b64_tr_b16 v[62:63], v21 offset:27136
  s_waitcnt lgkmcnt(6)
  v_mfma_f32_32x32x16_bf16 v[64:79], v[48:51], v[180:183], v[64:79]
  ds_read_b128 v[184:187], v14 offset:0
  ds_read_b64_tr_b16 v[32:33], v20 offset:20480
  ds_read_b64_tr_b16 v[34:35], v20 offset:20992
  s_waitcnt lgkmcnt(7)
  v_mfma_f32_32x32x16_bf16 v[80:95], v[52:55], v[180:183], v[80:95]
  ds_read_b64_tr_b16 v[36:37], v21 offset:20480
  ds_read_b64_tr_b16 v[38:39], v21 offset:20992
  s_waitcnt lgkmcnt(7)
  v_mfma_f32_32x32x16_bf16 v[96:111], v[56:59], v[180:183], v[96:111]
  ds_read_b64_tr_b16 v[40:41], v20 offset:28672
  ds_read_b64_tr_b16 v[42:43], v20 offset:29184
  s_waitcnt lgkmcnt(7)
  v_mfma_f32_32x32x16_bf16 v[112:127], v[60:63], v[180:183], v[112:127]
  ds_read_b64_tr_b16 v[44:45], v21 offset:28672
  ds_read_b64_tr_b16 v[46:47], v21 offset:29184
  s_waitcnt lgkmcnt(6)
  v_mfma_f32_32x32x16_bf16 v[64:79], v[32:35], v[184:187], v[64:79]
  ds_read_b128 v[188:191], v15 offset:0
  ds_read_b64_tr_b16 v[48:49], v20 offset:22528
  ds_read_b64_tr_b16 v[50:51], v20 offset:23040
  s_waitcnt lgkmcnt(7)
  v_mfma_f32_32x32x16_bf16 v[80:95], v[36:39], v[184:187], v[80:95]
  ds_read_b64_tr_b16 v[52:53], v21 offset:22528
  ds_read_b64_tr_b16 v[54:55], v21 offset:23040
  s_waitcnt lgkmcnt(7)
  v_mfma_f32_32x32x16_bf16 v[96:111], v[40:43], v[184:187], v[96:111]
  ds_read_b64_tr_b16 v[56:57], v20 offset:30720
  ds_read_b64_tr_b16 v[58:59], v20 offset:31232
  s_waitcnt lgkmcnt(7)
  v_mfma_f32_32x32x16_bf16 v[112:127], v[44:47], v[184:187], v[112:127]
  ds_read_b64_tr_b16 v[60:61], v21 offset:30720
  ds_read_b64_tr_b16 v[62:63], v21 offset:31232
  s_waitcnt lgkmcnt(6)
  v_mfma_f32_32x32x16_bf16 v[64:79], v[48:51], v[188:191], v[64:79]
  s_waitcnt lgkmcnt(4)
  v_mfma_f32_32x32x16_bf16 v[80:95], v[52:55], v[188:191], v[80:95]
  s_waitcnt lgkmcnt(0)
  s_barrier
  ds_read_b128 v[192:195], v12 offset:32768
  ds_read_b64_tr_b16 v[32:33], v20 offset:49152
  ds_read_b64_tr_b16 v[34:35], v20 offset:49664
  ds_read_b64_tr_b16 v[36:37], v21 offset:49152
  ds_read_b64_tr_b16 v[38:39], v21 offset:49664
  v_mfma_f32_32x32x16_bf16 v[96:111], v[56:59], v[188:191], v[96:111]
  ds_read_b64_tr_b16 v[40:41], v20 offset:57344
  ds_read_b64_tr_b16 v[42:43], v20 offset:57856
  ds_read_b64_tr_b16 v[44:45], v21 offset:57344
  ds_read_b64_tr_b16 v[46:47], v21 offset:57856
  v_mfma_f32_32x32x16_bf16 v[112:127], v[60:63], v[188:191], v[112:127]
  s_waitcnt lgkmcnt(6)
  v_mfma_f32_32x32x16_bf16 v[64:79], v[32:35], v[192:195], v[64:79]
  ds_read_b128 v[196:199], v13 offset:32768
  ds_read_b64_tr_b16 v[48:49], v20 offset:51200
  ds_read_b64_tr_b16 v[50:51], v20 offset:51712
  s_waitcnt lgkmcnt(7)
  v_mfma_f32_32x32x16_bf16 v[80:95], v[36:39], v[192:195], v[80:95]
  ds_read_b64_tr_b16 v[52:53], v21 offset:51200
  ds_read_b64_tr_b16 v[54:55], v21 offset:51712
  s_waitcnt lgkmcnt(7)
  v_mfma_f32_32x32x16_bf16 v[96:111], v[40:43], v[192:195], v[96:111]
  ds_read_b64_tr_b16 v[56:57], v20 offset:59392
  ds_read_b64_tr_b16 v[58:59], v20 offset:59904
  s_waitcnt lgkmcnt(7)
  v_mfma_f32_32x32x16_bf16 v[112:127], v[44:47], v[192:195], v[112:127]
  ds_read_b64_tr_b16 v[60:61], v21 offset:59392
  ds_read_b64_tr_b16 v[62:63], v21 offset:59904
  s_waitcnt lgkmcnt(6)
  v_mfma_f32_32x32x16_bf16 v[64:79], v[48:51], v[196:199], v[64:79]
  ds_read_b128 v[200:203], v14 offset:32768
  ds_read_b64_tr_b16 v[32:33], v20 offset:53248
  ds_read_b64_tr_b16 v[34:35], v20 offset:53760
  s_waitcnt lgkmcnt(7)
  v_mfma_f32_32x32x16_bf16 v[80:95], v[52:55], v[196:199], v[80:95]
  ds_read_b64_tr_b16 v[36:37], v21 offset:53248
  ds_read_b64_tr_b16 v[38:39], v21 offset:53760
  s_waitcnt lgkmcnt(7)
  v_mfma_f32_32x32x16_bf16 v[96:111], v[56:59], v[196:199], v[96:111]
  ds_read_b64_tr_b16 v[40:41], v20 offset:61440
  ds_read_b64_tr_b16 v[42:43], v20 offset:61952
  s_waitcnt lgkmcnt(7)
  v_mfma_f32_32x32x16_bf16 v[112:127], v[60:63], v[196:199], v[112:127]
  ds_read_b64_tr_b16 v[44:45], v21 offset:61440
  ds_read_b64_tr_b16 v[46:47], v21 offset:61952
  s_waitcnt lgkmcnt(6)
  v_mfma_f32_32x32x16_bf16 v[64:79], v[32:35], v[200:203], v[64:79]
  ds_read_b128 v[204:207], v15 offset:32768
  ds_read_b64_tr_b16 v[48:49], v20 offset:55296
  ds_read_b64_tr_b16 v[50:51], v20 offset:55808
  s_waitcnt lgkmcnt(7)
  v_mfma_f32_32x32x16_bf16 v[80:95], v[36:39], v[200:203], v[80:95]
  ds_read_b64_tr_b16 v[52:53], v21 offset:55296
  ds_read_b64_tr_b16 v[54:55], v21 offset:55808
  s_waitcnt lgkmcnt(7)
  v_mfma_f32_32x32x16_bf16 v[96:111], v[40:43], v[200:203], v[96:111]
  ds_read_b64_tr_b16 v[56:57], v20 offset:63488
  ds_read_b64_tr_b16 v[58:59], v20 offset:64000
  s_waitcnt lgkmcnt(7)
  v_mfma_f32_32x32x16_bf16 v[112:127], v[44:47], v[200:203], v[112:127]
  ds_read_b64_tr_b16 v[60:61], v21 offset:63488
  ds_read_b64_tr_b16 v[62:63], v21 offset:64000
  s_waitcnt lgkmcnt(6)
  v_mfma_f32_32x32x16_bf16 v[64:79], v[48:51], v[204:207], v[64:79]
  s_waitcnt lgkmcnt(4)
  v_mfma_f32_32x32x16_bf16 v[80:95], v[52:55], v[204:207], v[80:95]
  s_waitcnt lgkmcnt(0)
  s_barrier
  ds_read_b128 v[208:211], v16 offset:0
  ds_read_b64_tr_b16 v[32:33], v22 offset:16384
  ds_read_b64_tr_b16 v[34:35], v22 offset:16896
  ds_read_b64_tr_b16 v[36:37], v23 offset:16384
  ds_read_b64_tr_b16 v[38:39], v23 offset:16896
  v_mfma_f32_32x32x16_bf16 v[96:111], v[56:59], v[204:207], v[96:111]
  ds_read_b64_tr_b16 v[40:41], v22 offset:24576
  ds_read_b64_tr_b16 v[42:43], v22 offset:25088
  ds_read_b64_tr_b16 v[44:45], v23 offset:24576
  ds_read_b64_tr_b16 v[46:47], v23 offset:25088
  v_mfma_f32_32x32x16_bf16 v[112:127], v[60:63], v[204:207], v[112:127]
  s_waitcnt lgkmcnt(6)
  v_mfma_f32_32x32x16_bf16 v[64:79], v[32:35], v[208:211], v[64:79]
  ds_read_b128 v[212:215], v17 offset:0
  ds_read_b64_tr_b16 v[48:49], v22 offset:18432
  ds_read_b64_tr_b16 v[50:51], v22 offset:18944
  s_waitcnt lgkmcnt(7)
  v_mfma_f32_32x32x16_bf16 v[80:95], v[36:39], v[208:211], v[80:95]
  ds_read_b64_tr_b16 v[52:53], v23 offset:18432
  ds_read_b64_tr_b16 v[54:55], v23 offset:18944
  s_waitcnt lgkmcnt(7)
  v_mfma_f32_32x32x16_bf16 v[96:111], v[40:43], v[208:211], v[96:111]
  ds_read_b64_tr_b16 v[56:57], v22 offset:26624
  ds_read_b64_tr_b16 v[58:59], v22 offset:27136
  s_waitcnt lgkmcnt(7)
  v_mfma_f32_32x32x16_bf16 v[112:127], v[44:47], v[208:211], v[112:127]
  ds_read_b64_tr_b16 v[60:61], v23 offset:26624
  ds_read_b64_tr_b16 v[62:63], v23 offset:27136
  s_waitcnt lgkmcnt(6)
  v_mfma_f32_32x32x16_bf16 v[64:79], v[48:51], v[212:215], v[64:79]
  ds_read_b128 v[216:219], v18 offset:0
  ds_read_b64_tr_b16 v[32:33], v22 offset:20480
  ds_read_b64_tr_b16 v[34:35], v22 offset:20992
  s_waitcnt lgkmcnt(7)
  v_mfma_f32_32x32x16_bf16 v[80:95], v[52:55], v[212:215], v[80:95]
  ds_read_b64_tr_b16 v[36:37], v23 offset:20480
  ds_read_b64_tr_b16 v[38:39], v23 offset:20992
  s_waitcnt lgkmcnt(7)
  v_mfma_f32_32x32x16_bf16 v[96:111], v[56:59], v[212:215], v[96:111]
  ds_read_b64_tr_b16 v[40:41], v22 offset:28672
  ds_read_b64_tr_b16 v[42:43], v22 offset:29184
  s_waitcnt lgkmcnt(7)
  v_mfma_f32_32x32x16_bf16 v[112:127], v[60:63], v[212:215], v[112:127]
  ds_read_b64_tr_b16 v[44:45], v23 offset:28672
  ds_read_b64_tr_b16 v[46:47], v23 offset:29184
  s_waitcnt lgkmcnt(6)
  v_mfma_f32_32x32x16_bf16 v[64:79], v[32:35], v[216:219], v[64:79]
  ds_read_b128 v[220:223], v19 offset:0
  ds_read_b64_tr_b16 v[48:49], v22 offset:22528
  ds_read_b64_tr_b16 v[50:51], v22 offset:23040
  s_waitcnt lgkmcnt(7)
  v_mfma_f32_32x32x16_bf16 v[80:95], v[36:39], v[216:219], v[80:95]
  ds_read_b64_tr_b16 v[52:53], v23 offset:22528
  ds_read_b64_tr_b16 v[54:55], v23 offset:23040
  s_waitcnt lgkmcnt(7)
  v_mfma_f32_32x32x16_bf16 v[96:111], v[40:43], v[216:219], v[96:111]
  ds_read_b64_tr_b16 v[56:57], v22 offset:30720
  ds_read_b64_tr_b16 v[58:59], v22 offset:31232
  s_waitcnt lgkmcnt(7)
  v_mfma_f32_32x32x16_bf16 v[112:127], v[44:47], v[216:219], v[112:127]
  ds_read_b64_tr_b16 v[60:61], v23 offset:30720
  ds_read_b64_tr_b16 v[62:63], v23 offset:31232
  s_waitcnt lgkmcnt(6)
  v_mfma_f32_32x32x16_bf16 v[64:79], v[48:51], v[220:223], v[64:79]
  s_waitcnt lgkmcnt(4)
  v_mfma_f32_32x32x16_bf16 v[80:95], v[52:55], v[220:223], v[80:95]
  buffer_load_dwordx2 v[2:3], v26, s[16:19], s76 offen sc1
  s_waitcnt lgkmcnt(0)
  s_barrier
  ds_read_b128 v[224:227], v12 offset:0
  ds_read_b64_tr_b16 v[32:33], v20 offset:16384
  ds_read_b64_tr_b16 v[34:35], v20 offset:16896
  ds_read_b64_tr_b16 v[36:37], v21 offset:16384
  ds_read_b64_tr_b16 v[38:39], v21 offset:16896
  v_mfma_f32_32x32x16_bf16 v[96:111], v[56:59], v[220:223], v[96:111]
  ds_read_b64_tr_b16 v[40:41], v20 offset:24576
  ds_read_b64_tr_b16 v[42:43], v20 offset:25088
  ds_read_b64_tr_b16 v[44:45], v21 offset:24576
  ds_read_b64_tr_b16 v[46:47], v21 offset:25088
  v_mfma_f32_32x32x16_bf16 v[112:127], v[60:63], v[220:223], v[112:127]
  s_waitcnt lgkmcnt(6)
  v_mfma_f32_32x32x16_bf16 v[64:79], v[32:35], v[224:227], v[64:79]
  ds_read_b128 v[228:231], v13 offset:0
  ds_read_b64_tr_b16 v[48:49], v20 offset:18432
  ds_read_b64_tr_b16 v[50:51], v20 offset:18944
  s_waitcnt lgkmcnt(7)
  v_mfma_f32_32x32x16_bf16 v[80:95], v[36:39], v[224:227], v[80:95]
  ds_read_b64_tr_b16 v[52:53], v21 offset:18432
  ds_read_b64_tr_b16 v[54:55], v21 offset:18944
  s_waitcnt lgkmcnt(7)
  v_mfma_f32_32x32x16_bf16 v[96:111], v[40:43], v[224:227], v[96:111]
  ds_read_b64_tr_b16 v[56:57], v20 offset:26624
  ds_read_b64_tr_b16 v[58:59], v20 offset:27136
  s_waitcnt lgkmcnt(7)
  v_mfma_f32_32x32x16_bf16 v[112:127], v[44:47], v[224:227], v[112:127]
  ds_read_b64_tr_b16 v[60:61], v21 offset:26624
  ds_read_b64_tr_b16 v[62:63], v21 offset:27136
  s_waitcnt lgkmcnt(6)
  v_mfma_f32_32x32x16_bf16 v[64:79], v[48:51], v[228:231], v[64:79]
  ds_read_b128 v[232:235], v14 offset:0
  ds_read_b64_tr_b16 v[32:33], v20 offset:20480
  ds_read_b64_tr_b16 v[34:35], v20 offset:20992
  s_waitcnt lgkmcnt(7)
  v_mfma_f32_32x32x16_bf16 v[80:95], v[52:55], v[228:231], v[80:95]
  ds_read_b64_tr_b16 v[36:37], v21 offset:20480
  ds_read_b64_tr_b16 v[38:39], v21 offset:20992
  s_waitcnt lgkmcnt(7)
  v_mfma_f32_32x32x16_bf16 v[96:111], v[56:59], v[228:231], v[96:111]
  ds_read_b64_tr_b16 v[40:41], v20 offset:28672
  ds_read_b64_tr_b16 v[42:43], v20 offset:29184
  s_waitcnt lgkmcnt(7)
  v_mfma_f32_32x32x16_bf16 v[112:127], v[60:63], v[228:231], v[112:127]
  ds_read_b64_tr_b16 v[44:45], v21 offset:28672
  ds_read_b64_tr_b16 v[46:47], v21 offset:29184
  s_waitcnt lgkmcnt(6)
  v_mfma_f32_32x32x16_bf16 v[64:79], v[32:35], v[232:235], v[64:79]
  ds_read_b128 v[236:239], v15 offset:0
  ds_read_b64_tr_b16 v[48:49], v20 offset:22528
  ds_read_b64_tr_b16 v[50:51], v20 offset:23040
  s_waitcnt lgkmcnt(7)
  v_mfma_f32_32x32x16_bf16 v[80:95], v[36:39], v[232:235], v[80:95]
  ds_read_b64_tr_b16 v[52:53], v21 offset:22528
  ds_read_b64_tr_b16 v[54:55], v21 offset:23040
  s_waitcnt lgkmcnt(7)
  v_mfma_f32_32x32x16_bf16 v[96:111], v[40:43], v[232:235], v[96:111]
  ds_read_b64_tr_b16 v[56:57], v20 offset:30720
  ds_read_b64_tr_b16 v[58:59], v20 offset:31232
  s_waitcnt lgkmcnt(7)
  v_mfma_f32_32x32x16_bf16 v[112:127], v[44:47], v[232:235], v[112:127]
  ds_read_b64_tr_b16 v[60:61], v21 offset:30720
  ds_read_b64_tr_b16 v[62:63], v21 offset:31232
  s_waitcnt lgkmcnt(6)
  v_mfma_f32_32x32x16_bf16 v[64:79], v[48:51], v[236:239], v[64:79]
  s_waitcnt lgkmcnt(4)
  v_mfma_f32_32x32x16_bf16 v[80:95], v[52:55], v[236:239], v[80:95]
  s_waitcnt lgkmcnt(0)
  s_barrier
  ds_read_b128 v[240:243], v12 offset:32768
  ds_read_b64_tr_b16 v[32:33], v20 offset:49152
  ds_read_b64_tr_b16 v[34:35], v20 offset:49664
  ds_read_b64_tr_b16 v[36:37], v21 offset:49152
  ds_read_b64_tr_b16 v[38:39], v21 offset:49664
  v_mfma_f32_32x32x16_bf16 v[96:111], v[56:59], v[236:239], v[96:111]
  ds_read_b64_tr_b16 v[40:41], v20 offset:57344
  ds_read_b64_tr_b16 v[42:43], v20 offset:57856
  ds_read_b64_tr_b16 v[44:45], v21 offset:57344
  ds_read_b64_tr_b16 v[46:47], v21 offset:57856
  v_mfma_f32_32x32x16_bf16 v[112:127], v[60:63], v[236:239], v[112:127]
  s_waitcnt lgkmcnt(6)
  v_mfma_f32_32x32x16_bf16 v[64:79], v[32:35], v[240:243], v[64:79]
  ds_read_b128 v[244:247], v13 offset:32768
  ds_read_b64_tr_b16 v[48:49], v20 offset:51200
  ds_read_b64_tr_b16 v[50:51], v20 offset:51712
  s_waitcnt lgkmcnt(7)
  v_mfma_f32_32x32x16_bf16 v[80:95], v[36:39], v[240:243], v[80:95]
  ds_read_b64_tr_b16 v[52:53], v21 offset:51200
  ds_read_b64_tr_b16 v[54:55], v21 offset:51712
  s_waitcnt lgkmcnt(7)
  v_mfma_f32_32x32x16_bf16 v[96:111], v[40:43], v[240:243], v[96:111]
  ds_read_b64_tr_b16 v[56:57], v20 offset:59392
  ds_read_b64_tr_b16 v[58:59], v20 offset:59904
  s_waitcnt lgkmcnt(7)
  v_mfma_f32_32x32x16_bf16 v[112:127], v[44:47], v[240:243], v[112:127]
  ds_read_b64_tr_b16 v[60:61], v21 offset:59392
  ds_read_b64_tr_b16 v[62:63], v21 offset:59904
  s_waitcnt lgkmcnt(6)
  v_mfma_f32_32x32x16_bf16 v[64:79], v[48:51], v[244:247], v[64:79]
  ds_read_b128 v[248:251], v14 offset:32768
  ds_read_b64_tr_b16 v[32:33], v20 offset:53248
  ds_read_b64_tr_b16 v[34:35], v20 offset:53760
  s_waitcnt lgkmcnt(7)
  v_mfma_f32_32x32x16_bf16 v[80:95], v[52:55], v[244:247], v[80:95]
  ds_read_b64_tr_b16 v[36:37], v21 offset:53248
  ds_read_b64_tr_b16 v[38:39], v21 offset:53760
  s_waitcnt lgkmcnt(7)
  v_mfma_f32_32x32x16_bf16 v[96:111], v[56:59], v[244:247], v[96:111]
  ds_read_b64_tr_b16 v[40:41], v20 offset:61440
  ds_read_b64_tr_b16 v[42:43], v20 offset:61952
  s_waitcnt lgkmcnt(7)
  v_mfma_f32_32x32x16_bf16 v[112:127], v[60:63], v[244:247], v[112:127]
  ds_read_b64_tr_b16 v[44:45], v21 offset:61440
  ds_read_b64_tr_b16 v[46:47], v21 offset:61952
  s_waitcnt lgkmcnt(6)
  v_mfma_f32_32x32x16_bf16 v[64:79], v[32:35], v[248:251], v[64:79]
  s_waitcnt vmcnt(0)
  v_xor_b32 v27, s78, v3
  v_lshlrev_b32 v28, 4, v27
  v_cmp_ne_u32 vcc, 0, v28
  s_nop 1
  s_cbranch_vccz L_gr_x
  s_mov_b32 s71, 65536
L_gr:
  buffer_load_dwordx2 v[2:3], v26, s[16:19], s76 offen sc1
  s_waitcnt vmcnt(0)
  v_xor_b32 v27, s78, v3
  v_lshlrev_b32 v28, 4, v27
  v_cmp_ne_u32 vcc, 0, v28
  s_sub_u32 s71, s71, 1
  s_cbranch_scc1 L_gr_x
  s_cbranch_vccz L_gr_x
  s_sleep 2
  s_branch L_gr
L_gr_x:
  ds_read_b128 v[252:255], v15 offset:32768
  ds_read_b64_tr_b16 v[48:49], v20 offset:55296
  ds_read_b64_tr_b16 v[50:51], v20 offset:55808
  s_waitcnt lgkmcnt(7)
  v_mfma_f32_32x32x16_bf16 v[80:95], v[36:39], v[248:251], v[80:95]
  v_cmp_ne_u32 vcc, 0, v27
  s_mov_b32 s68, 0x01000100
  v_perm_b32 v4, v2, v2, s68
  s_or_b32 s57, vcc_lo, vcc_hi
  v_xor_b32 v4, 0x80008000, v4
  v_lshrrev_b32 v5, 16, v2
  ds_read_b64_tr_b16 v[52:53], v21 offset:55296
  ds_read_b64_tr_b16 v[54:55], v21 offset:55808
  s_waitcnt lgkmcnt(7)
  v_mfma_f32_32x32x16_bf16 v[96:111], v[40:43], v[248:251], v[96:111]
  v_and_b32 v10, 0xffff0000, v2
  v_rcp_f32 v16, v10
  v_mov_b32 v11, v10
  v_mul_f32 v6, 0xc0135761, v16
  v_mul_f32 v8, v16, v16
  v_mul_f32 v18, 0x3fb8aa3b, v16
  ds_read_b64_tr_b16 v[56:57], v20 offset:63488
  ds_read_b64_tr_b16 v[58:59], v20 offset:64000
  s_waitcnt lgkmcnt(7)
  v_mfma_f32_32x32x16_bf16 v[112:127], v[44:47], v[248:251], v[112:127]
  v_mul_f32 v8, v8, v16
  v_mov_b32 v17, v16
  v_mul_f32 v8, 0xbdd2d3e8, v8
  v_mov_b32 v7, v6
  v_mov_b32 v19, v18
  v_mov_b32 v9, v8
  ds_read_b64_tr_b16 v[60:61], v21 offset:63488
  ds_read_b64_tr_b16 v[62:63], v21 offset:64000
  s_waitcnt lgkmcnt(6)
  v_mfma_f32_32x32x16_bf16 v[64:79], v[48:51], v[252:255], v[64:79]
  s_waitcnt lgkmcnt(4)
  v_mfma_f32_32x32x16_bf16 v[80:95], v[52:55], v[252:255], v[80:95]
  s_waitcnt lgkmcnt(0)
  s_barrier
  v_mov_b32 v27, s57
  s_mov_b64 exec, 1
  ds_write_b32 v30, v27 offset:32
  s_mov_b64 exec, -1
  ds_read_b64 v[32:33], v29 offset:0
  ds_read_b64 v[34:35], v29 offset:512
  ds_read_b64 v[36:37], v29 offset:1024
  ds_read_b64 v[38:39], v29 offset:1536
  v_mfma_f32_32x32x16_bf16 v[96:111], v[56:59], v[252:255], v[96:111]
  v_mfma_f32_32x32x16_bf16 v[112:127], v[60:63], v[252:255], v[112:127]
  s_waitcnt lgkmcnt(3)
  v_mfma_f32_32x32x8bf16_1k v[64:79], v[32:33], v[4:5], v[64:79]
  s_waitcnt lgkmcnt(2)
  v_mfma_f32_32x32x8bf16_1k v[80:95], v[34:35], v[4:5], v[80:95]
  s_waitcnt lgkmcnt(1)
  v_mfma_f32_32x32x8bf16_1k v[96:111], v[36:37], v[4:5], v[96:111]
  s_waitcnt lgkmcnt(0)
  v_mfma_f32_32x32x8bf16_1k v[112:127], v[38:39], v[4:5], v[112:127]
  s_cmp_eq_u32 s63, 0
  s_nop 0
  s_cbranch_scc0 L_cB
  v_and_b32 v26, 31, v0
  v_lshrrev_b32 v27, 5, v0
  s_lshl_b32 s68, s59, 5
  v_add_u32 v26, s68, v26
  v_mul_u32_u24 v26, 272, v26
  v_lshl_add_u32 v26, v27, 3, v26
  v_add_u32 v26, 0xd000, v26
  v_pk_mul_f32 v[32:33], v[64:65], v[18:19]
  v_pk_mul_f32 v[34:35], v[66:67], v[18:19]
  v_pk_mul_f32 v[36:37], v[68:69], v[18:19]
  v_pk_mul_f32 v[38:39], v[70:71], v[18:19]
  v_pk_mul_f32 v[40:41], v[72:73], v[18:19]
  v_pk_mul_f32 v[42:43], v[74:75], v[18:19]
  v_pk_mul_f32 v[44:45], v[76:77], v[18:19]
  v_pk_mul_f32 v[46:47], v[78:79], v[18:19]
  v_exp_f32 v32, v32
  v_exp_f32 v33, v33
  v_exp_f32 v34, v34
  v_exp_f32 v35, v35
  v_exp_f32 v36, v36
  v_exp_f32 v37, v37
  v_exp_f32 v38, v38
  v_exp_f32 v39, v39
  v_exp_f32 v40, v40
  v_exp_f32 v41, v41
  v_exp_f32 v42, v42
  v_exp_f32 v43, v43
  v_exp_f32 v44, v44
  v_exp_f32 v45, v45
  v_exp_f32 v46, v46
  v_exp_f32 v47, v47
  v_pk_fma_f32 v[64:65], v[64:65], v[16:17], 1.0 op_sel_hi:[1,1,0]
  v_pk_fma_f32 v[66:67], v[66:67], v[16:17], 1.0 op_sel_hi:[1,1,0]
  v_pk_fma_f32 v[68:69], v[68:69], v[16:17], 1.0 op_sel_hi:[1,1,0]
  v_pk_fma_f32 v[70:71], v[70:71], v[16:17], 1.0 op_sel_hi:[1,1,0]
  v_pk_fma_f32 v[72:73], v[72:73], v[16:17], 1.0 op_sel_hi:[1,1,0]
  v_pk_fma_f32 v[74:75], v[74:75], v[16:17], 1.0 op_sel_hi:[1,1,0]
  v_pk_fma_f32 v[76:77], v[76:77], v[16:17], 1.0 op_sel_hi:[1,1,0]
  v_pk_fma_f32 v[78:79], v[78:79], v[16:17], 1.0 op_sel_hi:[1,1,0]
  v_med3_f32 v32, v32, v64, 1.0
  v_med3_f32 v33, v33, v65, 1.0
  v_med3_f32 v34, v34, v66, 1.0
  v_med3_f32 v35, v35, v67, 1.0
  v_med3_f32 v36, v36, v68, 1.0
  v_med3_f32 v37, v37, v69, 1.0
  v_med3_f32 v38, v38, v70, 1.0
  v_med3_f32 v39, v39, v71, 1.0
  v_med3_f32 v40, v40, v72, 1.0
  v_med3_f32 v41, v41, v73, 1.0
  v_med3_f32 v42, v42, v74, 1.0
  v_med3_f32 v43, v43, v75, 1.0
  v_med3_f32 v44, v44, v76, 1.0
  v_med3_f32 v45, v45, v77, 1.0
  v_med3_f32 v46, v46, v78, 1.0
  v_med3_f32 v47, v47, v79, 1.0
  v_pk_add_f32 v[32:33], v[32:33], s[74:75]
  v_pk_add_f32 v[34:35], v[34:35], s[74:75]
  v_pk_add_f32 v[36:37], v[36:37], s[74:75]
  v_pk_add_f32 v[38:39], v[38:39], s[74:75]
  v_pk_add_f32 v[40:41], v[40:41], s[74:75]
  v_pk_add_f32 v[42:43], v[42:43], s[74:75]
  v_pk_add_f32 v[44:45], v[44:45], s[74:75]
  v_pk_add_f32 v[46:47], v[46:47], s[74:75]
  v_cvt_pk_bf16_f32 v48, v32, v33
  v_cvt_pk_bf16_f32 v49, v34, v35
  v_cvt_pk_bf16_f32 v50, v36, v37
  v_cvt_pk_bf16_f32 v51, v38, v39
  v_cvt_pk_bf16_f32 v52, v40, v41
  v_cvt_pk_bf16_f32 v53, v42, v43
  v_cvt_pk_bf16_f32 v54, v44, v45
  v_cvt_pk_bf16_f32 v55, v46, v47
  ds_write_b64 v26, v[48:49] offset:0
  ds_write_b64 v26, v[50:51] offset:16
  ds_write_b64 v26, v[52:53] offset:32
  ds_write_b64 v26, v[54:55] offset:48
  v_pk_mul_f32 v[32:33], v[80:81], v[18:19]
  v_pk_mul_f32 v[34:35], v[82:83], v[18:19]
  v_pk_mul_f32 v[36:37], v[84:85], v[18:19]
  v_pk_mul_f32 v[38:39], v[86:87], v[18:19]
  v_pk_mul_f32 v[40:41], v[88:89], v[18:19]
  v_pk_mul_f32 v[42:43], v[90:91], v[18:19]
  v_pk_mul_f32 v[44:45], v[92:93], v[18:19]
  v_pk_mul_f32 v[46:47], v[94:95], v[18:19]
  v_exp_f32 v32, v32
  v_exp_f32 v33, v33
  v_exp_f32 v34, v34
  v_exp_f32 v35, v35
  v_exp_f32 v36, v36
  v_exp_f32 v37, v37
  v_exp_f32 v38, v38
  v_exp_f32 v39, v39
  v_exp_f32 v40, v40
  v_exp_f32 v41, v41
  v_exp_f32 v42, v42
  v_exp_f32 v43, v43
  v_exp_f32 v44, v44
  v_exp_f32 v45, v45
  v_exp_f32 v46, v46
  v_exp_f32 v47, v47
  v_pk_fma_f32 v[80:81], v[80:81], v[16:17], 1.0 op_sel_hi:[1,1,0]
  v_pk_fma_f32 v[82:83], v[82:83], v[16:17], 1.0 op_sel_hi:[1,1,0]
  v_pk_fma_f32 v[84:85], v[84:85], v[16:17], 1.0 op_sel_hi:[1,1,0]
  v_pk_fma_f32 v[86:87], v[86:87], v[16:17], 1.0 op_sel_hi:[1,1,0]
  v_pk_fma_f32 v[88:89], v[88:89], v[16:17], 1.0 op_sel_hi:[1,1,0]
  v_pk_fma_f32 v[90:91], v[90:91], v[16:17], 1.0 op_sel_hi:[1,1,0]
  v_pk_fma_f32 v[92:93], v[92:93], v[16:17], 1.0 op_sel_hi:[1,1,0]
  v_pk_fma_f32 v[94:95], v[94:95], v[16:17], 1.0 op_sel_hi:[1,1,0]
  v_med3_f32 v32, v32, v80, 1.0
  v_med3_f32 v33, v33, v81, 1.0
  v_med3_f32 v34, v34, v82, 1.0
  v_med3_f32 v35, v35, v83, 1.0
  v_med3_f32 v36, v36, v84, 1.0
  v_med3_f32 v37, v37, v85, 1.0
  v_med3_f32 v38, v38, v86, 1.0
  v_med3_f32 v39, v39, v87, 1.0
  v_med3_f32 v40, v40, v88, 1.0
  v_med3_f32 v41, v41, v89, 1.0
  v_med3_f32 v42, v42, v90, 1.0
  v_med3_f32 v43, v43, v91, 1.0
  v_med3_f32 v44, v44, v92, 1.0
  v_med3_f32 v45, v45, v93, 1.0
  v_med3_f32 v46, v46, v94, 1.0
  v_med3_f32 v47, v47, v95, 1.0
  v_pk_add_f32 v[32:33], v[32:33], s[74:75]
  v_pk_add_f32 v[34:35], v[34:35], s[74:75]
  v_pk_add_f32 v[36:37], v[36:37], s[74:75]
  v_pk_add_f32 v[38:39], v[38:39], s[74:75]
  v_pk_add_f32 v[40:41], v[40:41], s[74:75]
  v_pk_add_f32 v[42:43], v[42:43], s[74:75]
  v_pk_add_f32 v[44:45], v[44:45], s[74:75]
  v_pk_add_f32 v[46:47], v[46:47], s[74:75]
  v_cvt_pk_bf16_f32 v56, v32, v33
  v_cvt_pk_bf16_f32 v57, v34, v35
  v_cvt_pk_bf16_f32 v58, v36, v37
  v_cvt_pk_bf16_f32 v59, v38, v39
  v_cvt_pk_bf16_f32 v60, v40, v41
  v_cvt_pk_bf16_f32 v61, v42, v43
  v_cvt_pk_bf16_f32 v62, v44, v45
  v_cvt_pk_bf16_f32 v63, v46, v47
  ds_write_b64 v26, v[56:57] offset:64
  ds_write_b64 v26, v[58:59] offset:80
  ds_write_b64 v26, v[60:61] offset:96
  ds_write_b64 v26, v[62:63] offset:112
  v_pk_mul_f32 v[32:33], v[96:97], v[16:17]
  v_pk_mul_f32 v[34:35], v[98:99], v[16:17]
  v_pk_mul_f32 v[36:37], v[100:101], v[16:17]
  v_pk_mul_f32 v[38:39], v[102:103], v[16:17]
  v_pk_mul_f32 v[40:41], v[104:105], v[16:17]
  v_pk_mul_f32 v[42:43], v[106:107], v[16:17]
  v_pk_mul_f32 v[44:45], v[108:109], v[16:17]
  v_pk_mul_f32 v[46:47], v[110:111], v[16:17]
  v_cvt_pk_bf16_f32 v48, v32, v33
  v_cvt_pk_bf16_f32 v49, v34, v35
  v_cvt_pk_bf16_f32 v50, v36, v37
  v_cvt_pk_bf16_f32 v51, v38, v39
  v_cvt_pk_bf16_f32 v52, v40, v41
  v_cvt_pk_bf16_f32 v53, v42, v43
  v_cvt_pk_bf16_f32 v54, v44, v45
  v_cvt_pk_bf16_f32 v55, v46, v47
  ds_write_b64 v26, v[48:49] offset:128
  ds_write_b64 v26, v[50:51] offset:144
  ds_write_b64 v26, v[52:53] offset:160
  ds_write_b64 v26, v[54:55] offset:176
  v_pk_mul_f32 v[32:33], v[112:113], v[16:17]
  v_pk_mul_f32 v[34:35], v[114:115], v[16:17]
  v_pk_mul_f32 v[36:37], v[116:117], v[16:17]
  v_pk_mul_f32 v[38:39], v[118:119], v[16:17]
  v_pk_mul_f32 v[40:41], v[120:121], v[16:17]
  v_pk_mul_f32 v[42:43], v[122:123], v[16:17]
  v_pk_mul_f32 v[44:45], v[124:125], v[16:17]
  v_pk_mul_f32 v[46:47], v[126:127], v[16:17]
  v_cvt_pk_bf16_f32 v56, v32, v33
  v_cvt_pk_bf16_f32 v57, v34, v35
  v_cvt_pk_bf16_f32 v58, v36, v37
  v_cvt_pk_bf16_f32 v59, v38, v39
  v_cvt_pk_bf16_f32 v60, v40, v41
  v_cvt_pk_bf16_f32 v61, v42, v43
  v_cvt_pk_bf16_f32 v62, v44, v45
  v_cvt_pk_bf16_f32 v63, v46, v47
  ds_write_b64 v26, v[56:57] offset:192
  ds_write_b64 v26, v[58:59] offset:208
  ds_write_b64 v26, v[60:61] offset:224
  ds_write_b64 v26, v[62:63] offset:240
  v_lshrrev_b32 v26, 2, v0
  v_mul_u32_u24 v26, 272, v26
  v_and_b32 v27, 3, v0
  v_lshl_add_u32 v26, v27, 3, v26
  s_add_u32 s68, s68, 0xd000
  v_add_u32 v26, s68, v26
  v_mov_b32 v104, 0x3f803f80
  v_mov_b32 v105, 0x3f803f80
  v_mov_b32 v106, 0x3f803f80
  v_mov_b32 v107, 0x3f803f80
  s_lshl_b32 s68, s62, 4
  s_add_u32 s68, s68, s60
  s_mul_i32 s68, s68, 4352
  s_add_u32 s68, s68, 0x10000
  s_lshl_b32 s69, s59, 10
  s_add_u32 s69, s69, s68
  s_lshl_b32 s70, s59, 6
  s_add_u32 s70, s70, s68
  s_add_u32 s70, s70, 4096
  s_waitcnt lgkmcnt(0)
  v_mov_b32 v27, 1
  s_mov_b64 exec, 1
  ds_write_b32 v30, v27
  s_mov_b64 exec, -1
  v_add_u32 v3, 16, v31
  ds_read_b32 v27, v3
  s_waitcnt lgkmcnt(0)
  v_cmp_gt_u32 vcc, 1, v27
  s_nop 1
  s_cbranch_vccz L_w14_x
  s_mov_b32 s71, 1048576
L_w14:
  ds_read_b32 v27, v3
  s_sub_u32 s71, s71, 1
  s_waitcnt lgkmcnt(0)
  v_cmp_gt_u32 vcc, 1, v27
  s_cbranch_scc1 L_w14_x
  s_nop 0
  s_cbranch_vccnz L_w14
L_w14_x:
  ds_read_b64_tr_b16 v[64:65], v26 offset:0
  ds_read_b64_tr_b16 v[66:67], v26 offset:4352
  ds_read_b64_tr_b16 v[68:69], v26 offset:128
  ds_read_b64_tr_b16 v[70:71], v26 offset:4480
  ds_read_b64_tr_b16 v[72:73], v26 offset:8704
  ds_read_b64_tr_b16 v[74:75], v26 offset:13056
  ds_read_b64_tr_b16 v[76:77], v26 offset:8832
  ds_read_b64_tr_b16 v[78:79], v26 offset:13184
  ds_read_b64_tr_b16 v[80:81], v26 offset:17408
  ds_read_b64_tr_b16 v[82:83], v26 offset:21760
  ds_read_b64_tr_b16 v[84:85], v26 offset:17536
  ds_read_b64_tr_b16 v[86:87], v26 offset:21888
  s_waitcnt lgkmcnt(8)
  v_mfma_f32_16x16x32_bf16 v[96:99], v[64:67], v[68:71], 0
  v_mfma_f32_16x16x32_bf16 v[100:103], v[64:67], v[104:107], 0
  ds_read_b64_tr_b16 v[88:89], v26 offset:26112
  ds_read_b64_tr_b16 v[90:91], v26 offset:30464
  ds_read_b64_tr_b16 v[92:93], v26 offset:26240
  ds_read_b64_tr_b16 v[94:95], v26 offset:30592
  s_waitcnt lgkmcnt(8)
  v_mfma_f32_16x16x32_bf16 v[96:99], v[72:75], v[76:79], v[96:99]
  v_mfma_f32_16x16x32_bf16 v[100:103], v[72:75], v[104:107], v[100:103]
  s_waitcnt lgkmcnt(4)
  v_mfma_f32_16x16x32_bf16 v[96:99], v[80:83], v[84:87], v[96:99]
  v_mfma_f32_16x16x32_bf16 v[100:103], v[80:83], v[104:107], v[100:103]
  s_waitcnt lgkmcnt(0)
  v_mfma_f32_16x16x32_bf16 v[96:99], v[88:91], v[92:95], v[96:99]
  v_mfma_f32_16x16x32_bf16 v[100:103], v[88:91], v[104:107], v[100:103]
  v_mov_b32 v104, s58
  s_mov_b32 s68, 0x07060500
  s_nop 4
  v_perm_b32 v96, v96, v104, s68
  v_perm_b32 v100, v100, v104, s68
  s_mov_b32 s68, 0x07060501
  v_perm_b32 v97, v97, v104, s68
  v_perm_b32 v101, v101, v104, s68
  s_mov_b32 s68, 0x07060502
  v_perm_b32 v98, v98, v104, s68
  v_perm_b32 v102, v102, v104, s68
  s_mov_b32 s68, 0x07060503
  v_perm_b32 v99, v99, v104, s68
  v_perm_b32 v103, v103, v104, s68
  buffer_store_dwordx4 v[96:99], v1, s[16:19], s69 offen sc1
  s_mov_b32 exec_lo, 0x00010001
  s_mov_b32 exec_hi, 0x00010001
  buffer_store_dwordx4 v[100:103], v0, s[16:19], s70 offen sc1
  s_mov_b64 exec, -1
  v_mov_b32 v27, 2
  s_mov_b64 exec, 1
  ds_write_b32 v30, v27
  s_mov_b64 exec, -1
  ds_read_b32 v27, v31
  s_waitcnt lgkmcnt(0)
  v_cmp_gt_u32 vcc, 1, v27
  s_nop 1
  s_cbranch_vccz L_w15_x
  s_mov_b32 s71, 1048576
L_w15:
  ds_read_b32 v27, v31
  s_sub_u32 s71, s71, 1
  s_waitcnt lgkmcnt(0)
  v_cmp_gt_u32 vcc, 1, v27
  s_cbranch_scc1 L_w15_x
  s_nop 0
  s_cbranch_vccnz L_w15
L_w15_x:
  s_branch L_p2
L_cB:
  s_lshl_b32 s68, s59, 10
  s_add_u32 s68, s68, 0xd000
  v_add_u32 v26, s68, v1
  v_pk_mul_f32 v[32:33], v[64:65], v[64:65]
  v_pk_mul_f32 v[34:35], v[66:67], v[66:67]
  v_pk_mul_f32 v[36:37], v[68:69], v[68:69]
  v_pk_mul_f32 v[38:39], v[70:71], v[70:71]
  v_pk_mul_f32 v[40:41], v[72:73], v[72:73]
  v_pk_mul_f32 v[42:43], v[74:75], v[74:75]
  v_pk_mul_f32 v[44:45], v[76:77], v[76:77]
  v_pk_mul_f32 v[46:47], v[78:79], v[78:79]
  v_pk_fma_f32 v[32:33], v[32:33], v[8:9], v[6:7]
  v_pk_fma_f32 v[34:35], v[34:35], v[8:9], v[6:7]
  v_pk_fma_f32 v[36:37], v[36:37], v[8:9], v[6:7]
  v_pk_fma_f32 v[38:39], v[38:39], v[8:9], v[6:7]
  v_pk_fma_f32 v[40:41], v[40:41], v[8:9], v[6:7]
  v_pk_fma_f32 v[42:43], v[42:43], v[8:9], v[6:7]
  v_pk_fma_f32 v[44:45], v[44:45], v[8:9], v[6:7]
  v_pk_fma_f32 v[46:47], v[46:47], v[8:9], v[6:7]
  v_pk_mul_f32 v[32:33], v[32:33], v[64:65]
  v_pk_mul_f32 v[34:35], v[34:35], v[66:67]
  v_pk_mul_f32 v[36:37], v[36:37], v[68:69]
  v_pk_mul_f32 v[38:39], v[38:39], v[70:71]
  v_pk_mul_f32 v[40:41], v[40:41], v[72:73]
  v_pk_mul_f32 v[42:43], v[42:43], v[74:75]
  v_pk_mul_f32 v[44:45], v[44:45], v[76:77]
  v_pk_mul_f32 v[46:47], v[46:47], v[78:79]
  v_exp_f32 v32, v32
  v_exp_f32 v33, v33
  v_exp_f32 v34, v34
  v_exp_f32 v35, v35
  v_exp_f32 v36, v36
  v_exp_f32 v37, v37
  v_exp_f32 v38, v38
  v_exp_f32 v39, v39
  v_exp_f32 v40, v40
  v_exp_f32 v41, v41
  v_exp_f32 v42, v42
  v_exp_f32 v43, v43
  v_exp_f32 v44, v44
  v_exp_f32 v45, v45
  v_exp_f32 v46, v46
  v_exp_f32 v47, v47
  v_pk_fma_f32 v[32:33], v[32:33], v[10:11], v[10:11]
  v_pk_fma_f32 v[34:35], v[34:35], v[10:11], v[10:11]
  v_pk_fma_f32 v[36:37], v[36:37], v[10:11], v[10:11]
  v_pk_fma_f32 v[38:39], v[38:39], v[10:11], v[10:11]
  v_pk_fma_f32 v[40:41], v[40:41], v[10:11], v[10:11]
  v_pk_fma_f32 v[42:43], v[42:43], v[10:11], v[10:11]
  v_pk_fma_f32 v[44:45], v[44:45], v[10:11], v[10:11]
  v_pk_fma_f32 v[46:47], v[46:47], v[10:11], v[10:11]
  v_rcp_f32 v32, v32
  v_rcp_f32 v33, v33
  v_rcp_f32 v34, v34
  v_rcp_f32 v35, v35
  v_rcp_f32 v36, v36
  v_rcp_f32 v37, v37
  v_rcp_f32 v38, v38
  v_rcp_f32 v39, v39
  v_rcp_f32 v40, v40
  v_rcp_f32 v41, v41
  v_rcp_f32 v42, v42
  v_rcp_f32 v43, v43
  v_rcp_f32 v44, v44
  v_rcp_f32 v45, v45
  v_rcp_f32 v46, v46
  v_rcp_f32 v47, v47
  v_pk_mul_f32 v[32:33], v[32:33], v[64:65]
  v_pk_mul_f32 v[34:35], v[34:35], v[66:67]
  v_pk_mul_f32 v[36:37], v[36:37], v[68:69]
  v_pk_mul_f32 v[38:39], v[38:39], v[70:71]
  v_pk_mul_f32 v[40:41], v[40:41], v[72:73]
  v_pk_mul_f32 v[42:43], v[42:43], v[74:75]
  v_pk_mul_f32 v[44:45], v[44:45], v[76:77]
  v_pk_mul_f32 v[46:47], v[46:47], v[78:79]
  v_cvt_pk_bf16_f32 v64, v32, v33
  v_cvt_pk_bf16_f32 v65, v34, v35
  v_cvt_pk_bf16_f32 v66, v36, v37
  v_cvt_pk_bf16_f32 v67, v38, v39
  v_cvt_pk_bf16_f32 v68, v40, v41
  v_cvt_pk_bf16_f32 v69, v42, v43
  v_cvt_pk_bf16_f32 v70, v44, v45
  v_cvt_pk_bf16_f32 v71, v46, v47
  ds_write_b128 v26, v[64:67] offset:0
  ds_write_b128 v26, v[68:71] offset:4096
  v_pk_mul_f32 v[32:33], v[80:81], v[80:81]
  v_pk_mul_f32 v[34:35], v[82:83], v[82:83]
  v_pk_mul_f32 v[36:37], v[84:85], v[84:85]
  v_pk_mul_f32 v[38:39], v[86:87], v[86:87]
  v_pk_mul_f32 v[40:41], v[88:89], v[88:89]
  v_pk_mul_f32 v[42:43], v[90:91], v[90:91]
  v_pk_mul_f32 v[44:45], v[92:93], v[92:93]
  v_pk_mul_f32 v[46:47], v[94:95], v[94:95]
  v_pk_fma_f32 v[32:33], v[32:33], v[8:9], v[6:7]
  v_pk_fma_f32 v[34:35], v[34:35], v[8:9], v[6:7]
  v_pk_fma_f32 v[36:37], v[36:37], v[8:9], v[6:7]
  v_pk_fma_f32 v[38:39], v[38:39], v[8:9], v[6:7]
  v_pk_fma_f32 v[40:41], v[40:41], v[8:9], v[6:7]
  v_pk_fma_f32 v[42:43], v[42:43], v[8:9], v[6:7]
  v_pk_fma_f32 v[44:45], v[44:45], v[8:9], v[6:7]
  v_pk_fma_f32 v[46:47], v[46:47], v[8:9], v[6:7]
  v_pk_mul_f32 v[32:33], v[32:33], v[80:81]
  v_pk_mul_f32 v[34:35], v[34:35], v[82:83]
  v_pk_mul_f32 v[36:37], v[36:37], v[84:85]
  v_pk_mul_f32 v[38:39], v[38:39], v[86:87]
  v_pk_mul_f32 v[40:41], v[40:41], v[88:89]
  v_pk_mul_f32 v[42:43], v[42:43], v[90:91]
  v_pk_mul_f32 v[44:45], v[44:45], v[92:93]
  v_pk_mul_f32 v[46:47], v[46:47], v[94:95]
  s_waitcnt lgkmcnt(0)
  v_mov_b32 v27, 1
  s_mov_b64 exec, 1
  ds_write_b32 v30, v27
  s_mov_b64 exec, -1
  v_exp_f32 v32, v32
  v_exp_f32 v33, v33
  v_exp_f32 v34, v34
  v_exp_f32 v35, v35
  v_exp_f32 v36, v36
  v_exp_f32 v37, v37
  v_exp_f32 v38, v38
  v_exp_f32 v39, v39
  v_exp_f32 v40, v40
  v_exp_f32 v41, v41
  v_exp_f32 v42, v42
  v_exp_f32 v43, v43
  v_exp_f32 v44, v44
  v_exp_f32 v45, v45
  v_exp_f32 v46, v46
  v_exp_f32 v47, v47
  v_pk_fma_f32 v[32:33], v[32:33], v[10:11], v[10:11]
  v_pk_fma_f32 v[34:35], v[34:35], v[10:11], v[10:11]
  v_pk_fma_f32 v[36:37], v[36:37], v[10:11], v[10:11]
  v_pk_fma_f32 v[38:39], v[38:39], v[10:11], v[10:11]
  v_pk_fma_f32 v[40:41], v[40:41], v[10:11], v[10:11]
  v_pk_fma_f32 v[42:43], v[42:43], v[10:11], v[10:11]
  v_pk_fma_f32 v[44:45], v[44:45], v[10:11], v[10:11]
  v_pk_fma_f32 v[46:47], v[46:47], v[10:11], v[10:11]
  v_rcp_f32 v32, v32
  v_rcp_f32 v33, v33
  v_rcp_f32 v34, v34
  v_rcp_f32 v35, v35
  v_rcp_f32 v36, v36
  v_rcp_f32 v37, v37
  v_rcp_f32 v38, v38
  v_rcp_f32 v39, v39
  v_rcp_f32 v40, v40
  v_rcp_f32 v41, v41
  v_rcp_f32 v42, v42
  v_rcp_f32 v43, v43
  v_rcp_f32 v44, v44
  v_rcp_f32 v45, v45
  v_rcp_f32 v46, v46
  v_rcp_f32 v47, v47
  v_pk_mul_f32 v[32:33], v[32:33], v[80:81]
  v_pk_mul_f32 v[34:35], v[34:35], v[82:83]
  v_pk_mul_f32 v[36:37], v[36:37], v[84:85]
  v_pk_mul_f32 v[38:39], v[38:39], v[86:87]
  v_pk_mul_f32 v[40:41], v[40:41], v[88:89]
  v_pk_mul_f32 v[42:43], v[42:43], v[90:91]
  v_pk_mul_f32 v[44:45], v[44:45], v[92:93]
  v_pk_mul_f32 v[46:47], v[46:47], v[94:95]
  v_cvt_pk_bf16_f32 v80, v32, v33
  v_cvt_pk_bf16_f32 v81, v34, v35
  v_cvt_pk_bf16_f32 v82, v36, v37
  v_cvt_pk_bf16_f32 v83, v38, v39
  v_cvt_pk_bf16_f32 v84, v40, v41
  v_cvt_pk_bf16_f32 v85, v42, v43
  v_cvt_pk_bf16_f32 v86, v44, v45
  v_cvt_pk_bf16_f32 v87, v46, v47
  ds_write_b128 v26, v[80:83] offset:8192
  ds_write_b128 v26, v[84:87] offset:12288
  v_pk_mul_f32 v[32:33], v[96:97], v[96:97]
  v_pk_mul_f32 v[34:35], v[98:99], v[98:99]
  v_pk_mul_f32 v[36:37], v[100:101], v[100:101]
  v_pk_mul_f32 v[38:39], v[102:103], v[102:103]
  v_pk_mul_f32 v[40:41], v[104:105], v[104:105]
  v_pk_mul_f32 v[42:43], v[106:107], v[106:107]
  v_pk_mul_f32 v[44:45], v[108:109], v[108:109]
  v_pk_mul_f32 v[46:47], v[110:111], v[110:111]
  v_pk_fma_f32 v[32:33], v[32:33], v[8:9], v[6:7]
  v_pk_fma_f32 v[34:35], v[34:35], v[8:9], v[6:7]
  v_pk_fma_f32 v[36:37], v[36:37], v[8:9], v[6:7]
  v_pk_fma_f32 v[38:39], v[38:39], v[8:9], v[6:7]
  v_pk_fma_f32 v[40:41], v[40:41], v[8:9], v[6:7]
  v_pk_fma_f32 v[42:43], v[42:43], v[8:9], v[6:7]
  v_pk_fma_f32 v[44:45], v[44:45], v[8:9], v[6:7]
  v_pk_fma_f32 v[46:47], v[46:47], v[8:9], v[6:7]
  v_pk_mul_f32 v[32:33], v[32:33], v[96:97]
  v_pk_mul_f32 v[34:35], v[34:35], v[98:99]
  v_pk_mul_f32 v[36:37], v[36:37], v[100:101]
  v_pk_mul_f32 v[38:39], v[38:39], v[102:103]
  v_pk_mul_f32 v[40:41], v[40:41], v[104:105]
  v_pk_mul_f32 v[42:43], v[42:43], v[106:107]
  v_pk_mul_f32 v[44:45], v[44:45], v[108:109]
  v_pk_mul_f32 v[46:47], v[46:47], v[110:111]
  s_waitcnt lgkmcnt(0)
  v_mov_b32 v27, 2
  s_mov_b64 exec, 1
  ds_write_b32 v30, v27
  s_mov_b64 exec, -1
  v_exp_f32 v32, v32
  v_exp_f32 v33, v33
  v_exp_f32 v34, v34
  v_exp_f32 v35, v35
  v_exp_f32 v36, v36
  v_exp_f32 v37, v37
  v_exp_f32 v38, v38
  v_exp_f32 v39, v39
  v_exp_f32 v40, v40
  v_exp_f32 v41, v41
  v_exp_f32 v42, v42
  v_exp_f32 v43, v43
  v_exp_f32 v44, v44
  v_exp_f32 v45, v45
  v_exp_f32 v46, v46
  v_exp_f32 v47, v47
  v_pk_fma_f32 v[32:33], v[32:33], v[10:11], v[10:11]
  v_pk_fma_f32 v[34:35], v[34:35], v[10:11], v[10:11]
  v_pk_fma_f32 v[36:37], v[36:37], v[10:11], v[10:11]
  v_pk_fma_f32 v[38:39], v[38:39], v[10:11], v[10:11]
  v_pk_fma_f32 v[40:41], v[40:41], v[10:11], v[10:11]
  v_pk_fma_f32 v[42:43], v[42:43], v[10:11], v[10:11]
  v_pk_fma_f32 v[44:45], v[44:45], v[10:11], v[10:11]
  v_pk_fma_f32 v[46:47], v[46:47], v[10:11], v[10:11]
  v_rcp_f32 v32, v32
  v_rcp_f32 v33, v33
  v_rcp_f32 v34, v34
  v_rcp_f32 v35, v35
  v_rcp_f32 v36, v36
  v_rcp_f32 v37, v37
  v_rcp_f32 v38, v38
  v_rcp_f32 v39, v39
  v_rcp_f32 v40, v40
  v_rcp_f32 v41, v41
  v_rcp_f32 v42, v42
  v_rcp_f32 v43, v43
  v_rcp_f32 v44, v44
  v_rcp_f32 v45, v45
  v_rcp_f32 v46, v46
  v_rcp_f32 v47, v47
  v_pk_mul_f32 v[32:33], v[32:33], v[96:97]
  v_pk_mul_f32 v[34:35], v[34:35], v[98:99]
  v_pk_mul_f32 v[36:37], v[36:37], v[100:101]
  v_pk_mul_f32 v[38:39], v[38:39], v[102:103]
  v_pk_mul_f32 v[40:41], v[40:41], v[104:105]
  v_pk_mul_f32 v[42:43], v[42:43], v[106:107]
  v_pk_mul_f32 v[44:45], v[44:45], v[108:109]
  v_pk_mul_f32 v[46:47], v[46:47], v[110:111]
  v_cvt_pk_bf16_f32 v96, v32, v33
  v_cvt_pk_bf16_f32 v97, v34, v35
  v_cvt_pk_bf16_f32 v98, v36, v37
  v_cvt_pk_bf16_f32 v99, v38, v39
  v_cvt_pk_bf16_f32 v100, v40, v41
  v_cvt_pk_bf16_f32 v101, v42, v43
  v_cvt_pk_bf16_f32 v102, v44, v45
  v_cvt_pk_bf16_f32 v103, v46, v47
  ds_write_b128 v26, v[96:99] offset:16384
  ds_write_b128 v26, v[100:103] offset:20480
  v_pk_mul_f32 v[32:33], v[112:113], v[112:113]
  v_pk_mul_f32 v[34:35], v[114:115], v[114:115]
  v_pk_mul_f32 v[36:37], v[116:117], v[116:117]
  v_pk_mul_f32 v[38:39], v[118:119], v[118:119]
  v_pk_mul_f32 v[40:41], v[120:121], v[120:121]
  v_pk_mul_f32 v[42:43], v[122:123], v[122:123]
  v_pk_mul_f32 v[44:45], v[124:125], v[124:125]
  v_pk_mul_f32 v[46:47], v[126:127], v[126:127]
  v_pk_fma_f32 v[32:33], v[32:33], v[8:9], v[6:7]
  v_pk_fma_f32 v[34:35], v[34:35], v[8:9], v[6:7]
  v_pk_fma_f32 v[36:37], v[36:37], v[8:9], v[6:7]
  v_pk_fma_f32 v[38:39], v[38:39], v[8:9], v[6:7]
  v_pk_fma_f32 v[40:41], v[40:41], v[8:9], v[6:7]
  v_pk_fma_f32 v[42:43], v[42:43], v[8:9], v[6:7]
  v_pk_fma_f32 v[44:45], v[44:45], v[8:9], v[6:7]
  v_pk_fma_f32 v[46:47], v[46:47], v[8:9], v[6:7]
  v_pk_mul_f32 v[32:33], v[32:33], v[112:113]
  v_pk_mul_f32 v[34:35], v[34:35], v[114:115]
  v_pk_mul_f32 v[36:37], v[36:37], v[116:117]
  v_pk_mul_f32 v[38:39], v[38:39], v[118:119]
  v_pk_mul_f32 v[40:41], v[40:41], v[120:121]
  v_pk_mul_f32 v[42:43], v[42:43], v[122:123]
  v_pk_mul_f32 v[44:45], v[44:45], v[124:125]
  v_pk_mul_f32 v[46:47], v[46:47], v[126:127]
  s_waitcnt lgkmcnt(0)
  v_mov_b32 v27, 3
  s_mov_b64 exec, 1
  ds_write_b32 v30, v27
  s_mov_b64 exec, -1
  v_exp_f32 v32, v32
  v_exp_f32 v33, v33
  v_exp_f32 v34, v34
  v_exp_f32 v35, v35
  v_exp_f32 v36, v36
  v_exp_f32 v37, v37
  v_exp_f32 v38, v38
  v_exp_f32 v39, v39
  v_exp_f32 v40, v40
  v_exp_f32 v41, v41
  v_exp_f32 v42, v42
  v_exp_f32 v43, v43
  v_exp_f32 v44, v44
  v_exp_f32 v45, v45
  v_exp_f32 v46, v46
  v_exp_f32 v47, v47
  v_pk_fma_f32 v[32:33], v[32:33], v[10:11], v[10:11]
  v_pk_fma_f32 v[34:35], v[34:35], v[10:11], v[10:11]
  v_pk_fma_f32 v[36:37], v[36:37], v[10:11], v[10:11]
  v_pk_fma_f32 v[38:39], v[38:39], v[10:11], v[10:11]
  v_pk_fma_f32 v[40:41], v[40:41], v[10:11], v[10:11]
  v_pk_fma_f32 v[42:43], v[42:43], v[10:11], v[10:11]
  v_pk_fma_f32 v[44:45], v[44:45], v[10:11], v[10:11]
  v_pk_fma_f32 v[46:47], v[46:47], v[10:11], v[10:11]
  v_rcp_f32 v32, v32
  v_rcp_f32 v33, v33
  v_rcp_f32 v34, v34
  v_rcp_f32 v35, v35
  v_rcp_f32 v36, v36
  v_rcp_f32 v37, v37
  v_rcp_f32 v38, v38
  v_rcp_f32 v39, v39
  v_rcp_f32 v40, v40
  v_rcp_f32 v41, v41
  v_rcp_f32 v42, v42
  v_rcp_f32 v43, v43
  v_rcp_f32 v44, v44
  v_rcp_f32 v45, v45
  v_rcp_f32 v46, v46
  v_rcp_f32 v47, v47
  v_pk_mul_f32 v[32:33], v[32:33], v[112:113]
  v_pk_mul_f32 v[34:35], v[34:35], v[114:115]
  v_pk_mul_f32 v[36:37], v[36:37], v[116:117]
  v_pk_mul_f32 v[38:39], v[38:39], v[118:119]
  v_pk_mul_f32 v[40:41], v[40:41], v[120:121]
  v_pk_mul_f32 v[42:43], v[42:43], v[122:123]
  v_pk_mul_f32 v[44:45], v[44:45], v[124:125]
  v_pk_mul_f32 v[46:47], v[46:47], v[126:127]
  v_cvt_pk_bf16_f32 v112, v32, v33
  v_cvt_pk_bf16_f32 v113, v34, v35
  v_cvt_pk_bf16_f32 v114, v36, v37
  v_cvt_pk_bf16_f32 v115, v38, v39
  v_cvt_pk_bf16_f32 v116, v40, v41
  v_cvt_pk_bf16_f32 v117, v42, v43
  v_cvt_pk_bf16_f32 v118, v44, v45
  v_cvt_pk_bf16_f32 v119, v46, v47
  ds_write_b128 v26, v[112:115] offset:24576
  ds_write_b128 v26, v[116:119] offset:28672
  s_waitcnt lgkmcnt(0)
  v_mov_b32 v27, 4
  s_mov_b64 exec, 1
  ds_write_b32 v30, v27
  s_mov_b64 exec, -1
  ds_read_b32 v28, v31
  s_waitcnt lgkmcnt(0)
  v_cmp_gt_u32 vcc, 1, v28
  s_nop 1
  s_cbranch_vccz L_w16_x
  s_mov_b32 s71, 1048576
L_w16:
  ds_read_b32 v28, v31
  s_sub_u32 s71, s71, 1
  s_waitcnt lgkmcnt(0)
  v_cmp_gt_u32 vcc, 1, v28
  s_cbranch_scc1 L_w16_x
  s_nop 0
  s_cbranch_vccnz L_w16
L_w16_x:
  s_cmp_lt_u32 s62, 3
  s_cbranch_scc1 L_p2
  ds_read_b64_tr_b16 v[32:33], v24 offset:8192
  ds_read_b64_tr_b16 v[34:35], v24 offset:8704
  ds_read_b64_tr_b16 v[36:37], v24 offset:10240
  ds_read_b64_tr_b16 v[38:39], v24 offset:10752
  ds_read_b64_tr_b16 v[40:41], v24 offset:12288
  ds_read_b64_tr_b16 v[42:43], v24 offset:12800
  ds_read_b64_tr_b16 v[44:45], v24 offset:14336
  ds_read_b64_tr_b16 v[46:47], v24 offset:14848
  ds_read_b64_tr_b16 v[48:49], v24 offset:16384
  ds_read_b64_tr_b16 v[50:51], v24 offset:16896
  ds_read_b64_tr_b16 v[52:53], v24 offset:18432
  ds_read_b64_tr_b16 v[54:55], v24 offset:18944
  s_waitcnt lgkmcnt(14)
  ds_read_b64_tr_b16 v[56:57], v24 offset:20480
  s_waitcnt lgkmcnt(14)
  ds_read_b64_tr_b16 v[58:59], v24 offset:20992
  s_waitcnt lgkmcnt(12)
  v_mfma_f32_32x32x16_bf16 v[64:79], v[32:35], v[128:131], 0
  ds_read_b64_tr_b16 v[60:61], v24 offset:22528
  ds_read_b64_tr_b16 v[62:63], v24 offset:23040
  s_waitcnt lgkmcnt(12)
  v_mfma_f32_32x32x16_bf16 v[64:79], v[36:39], v[132:135], v[64:79]
  ds_read_b64_tr_b16 v[32:33], v24 offset:24576
  ds_read_b64_tr_b16 v[34:35], v24 offset:25088
  s_waitcnt lgkmcnt(12)
  v_mfma_f32_32x32x16_bf16 v[64:79], v[40:43], v[136:139], v[64:79]
  ds_read_b64_tr_b16 v[36:37], v24 offset:26624
  ds_read_b64_tr_b16 v[38:39], v24 offset:27136
  v_and_b32 v107, 31, v0
  v_lshlrev_b32 v107, 2, v107
  s_waitcnt lgkmcnt(12)
  v_mfma_f32_32x32x16_bf16 v[64:79], v[44:47], v[140:143], v[64:79]
  ds_read_b64_tr_b16 v[40:41], v24 offset:28672
  ds_read_b64_tr_b16 v[42:43], v24 offset:29184
  v_and_b32 v106, 28, v107
  v_lshrrev_b32 v113, 5, v0
  s_waitcnt lgkmcnt(12)
  v_mfma_f32_32x32x16_bf16 v[64:79], v[48:51], v[144:147], v[64:79]
  ds_read_b64_tr_b16 v[44:45], v24 offset:30720
  ds_read_b64_tr_b16 v[46:47], v24 offset:31232
  v_bfe_u32 v114, v0, 2, 2
  v_lshl_add_u32 v113, v113, 2, v114
  s_waitcnt lgkmcnt(12)
  v_mfma_f32_32x32x16_bf16 v[64:79], v[52:55], v[148:151], v[64:79]
  ds_read_b64_tr_b16 v[48:49], v24 offset:32768
  ds_read_b64_tr_b16 v[50:51], v24 offset:33280
  v_lshlrev_b32 v96, 7, v113
  v_bfe_u32 v113, v0, 3, 1
  s_waitcnt lgkmcnt(12)
  v_mfma_f32_32x32x16_bf16 v[64:79], v[56:59], v[152:155], v[64:79]
  ds_read_b64_tr_b16 v[52:53], v24 offset:34816
  ds_read_b64_tr_b16 v[54:55], v24 offset:35328
  v_lshl_or_b32 v96, v113, 6, v96
  v_bfe_u32 v113, v0, 4, 1
  buffer_load_dword v104, v106, s[16:19], s51 offen sc1
  s_waitcnt lgkmcnt(12)
  v_mfma_f32_32x32x16_bf16 v[64:79], v[60:63], v[156:159], v[64:79]
  ds_read_b64_tr_b16 v[56:57], v24 offset:36864
  ds_read_b64_tr_b16 v[58:59], v24 offset:37376
  v_lshl_or_b32 v96, v113, 5, v96
  v_and_b32 v113, 3, v0
  s_waitcnt lgkmcnt(12)
  v_mfma_f32_32x32x16_bf16 v[64:79], v[32:35], v[160:163], v[64:79]
  ds_read_b64_tr_b16 v[60:61], v24 offset:38912
  ds_read_b64_tr_b16 v[62:63], v24 offset:39424
  v_lshl_or_b32 v96, v113, 3, v96
  v_add_u32 v96, s72, v96
  s_waitcnt lgkmcnt(12)
  v_mfma_f32_32x32x16_bf16 v[64:79], v[36:39], v[164:167], v[64:79]
  ds_read_b64_tr_b16 v[32:33], v24 offset:40960
  ds_read_b64_tr_b16 v[34:35], v24 offset:41472
  v_xor_b32 v97, 64, v96
  v_add_u32 v98, 0x10000, v96
  s_waitcnt lgkmcnt(12)
  v_mfma_f32_32x32x16_bf16 v[64:79], v[40:43], v[168:171], v[64:79]
  ds_read_b64_tr_b16 v[36:37], v24 offset:43008
  ds_read_b64_tr_b16 v[38:39], v24 offset:43520
  v_add_u32 v99, 0x10000, v97
  v_add_u32 v100, 0x20000, v96
  s_waitcnt lgkmcnt(12)
  v_mfma_f32_32x32x16_bf16 v[64:79], v[44:47], v[172:175], v[64:79]
  ds_read_b64_tr_b16 v[40:41], v24 offset:45056
  ds_read_b64_tr_b16 v[42:43], v24 offset:45568
  v_add_u32 v101, 0x20000, v97
  v_lshrrev_b32 v113, 1, s72
  s_waitcnt lgkmcnt(12)
  v_mfma_f32_32x32x16_bf16 v[64:79], v[48:51], v[176:179], v[64:79]
  ds_read_b64_tr_b16 v[44:45], v24 offset:47104
  ds_read_b64_tr_b16 v[46:47], v24 offset:47616
  v_add_u32 v102, v113, v1
  v_add_u32 v103, 0x1000, v102
  s_waitcnt lgkmcnt(12)
  v_mfma_f32_32x32x16_bf16 v[64:79], v[52:55], v[180:183], v[64:79]
  ds_read_b64_tr_b16 v[48:49], v24 offset:49152
  ds_read_b64_tr_b16 v[50:51], v24 offset:49664
  v_lshrrev_b32 v113, 5, v0
  v_and_b32 v114, 7, v0
  s_waitcnt lgkmcnt(12)
  v_mfma_f32_32x32x16_bf16 v[64:79], v[56:59], v[184:187], v[64:79]
  ds_read_b64_tr_b16 v[52:53], v24 offset:51200
  ds_read_b64_tr_b16 v[54:55], v24 offset:51712
  v_xor_b32 v113, v113, v114
  v_lshlrev_b32 v113, 4, v113
  s_waitcnt lgkmcnt(12)
  v_mfma_f32_32x32x16_bf16 v[64:79], v[60:63], v[188:191], v[64:79]
  ds_read_b64_tr_b16 v[56:57], v24 offset:53248
  ds_read_b64_tr_b16 v[58:59], v24 offset:53760
  v_and_b32 v114, 31, v0
  v_lshl_or_b32 v113, v114, 8, v113
  s_waitcnt lgkmcnt(12)
  v_mfma_f32_32x32x16_bf16 v[64:79], v[32:35], v[192:195], v[64:79]
  ds_read_b64_tr_b16 v[60:61], v24 offset:55296
  ds_read_b64_tr_b16 v[62:63], v24 offset:55808
  v_add_u32 v108, s73, v113
  v_xor_b32 v109, 32, v108
  s_waitcnt lgkmcnt(12)
  v_mfma_f32_32x32x16_bf16 v[64:79], v[36:39], v[196:199], v[64:79]
  ds_read_b64_tr_b16 v[32:33], v24 offset:57344
  ds_read_b64_tr_b16 v[34:35], v24 offset:57856
  v_xor_b32 v110, 64, v108
  v_xor_b32 v111, 96, v108
  s_waitcnt lgkmcnt(12)
  v_mfma_f32_32x32x16_bf16 v[64:79], v[40:43], v[200:203], v[64:79]
  ds_read_b64_tr_b16 v[36:37], v24 offset:59392
  ds_read_b64_tr_b16 v[38:39], v24 offset:59904
  v_add_u32 v112, 16, v31
  v_add_u32 v116, s15, v108
  s_waitcnt lgkmcnt(12)
  v_mfma_f32_32x32x16_bf16 v[64:79], v[44:47], v[204:207], v[64:79]
  ds_read_b64_tr_b16 v[40:41], v24 offset:61440
  ds_read_b64_tr_b16 v[42:43], v24 offset:61952
  v_add_u32 v117, s15, v109
  v_add_u32 v118, s15, v110
  s_waitcnt lgkmcnt(12)
  v_mfma_f32_32x32x16_bf16 v[64:79], v[48:51], v[208:211], v[64:79]
  ds_read_b64_tr_b16 v[44:45], v24 offset:63488
  ds_read_b64_tr_b16 v[46:47], v24 offset:64000
  v_add_u32 v119, s15, v111
  s_waitcnt lgkmcnt(12)
  v_mfma_f32_32x32x16_bf16 v[64:79], v[52:55], v[212:215], v[64:79]
  ds_read_b64_tr_b16 v[48:49], v24 offset:0
  ds_read_b64_tr_b16 v[50:51], v24 offset:512
  s_waitcnt lgkmcnt(12)
  v_mfma_f32_32x32x16_bf16 v[64:79], v[56:59], v[216:219], v[64:79]
  ds_read_b64_tr_b16 v[52:53], v24 offset:2048
  ds_read_b64_tr_b16 v[54:55], v24 offset:2560
  s_waitcnt lgkmcnt(12)
  v_mfma_f32_32x32x16_bf16 v[64:79], v[60:63], v[220:223], v[64:79]
  ds_read_b64_tr_b16 v[56:57], v24 offset:4096
  ds_read_b64_tr_b16 v[58:59], v24 offset:4608
  s_waitcnt lgkmcnt(12)
  v_mfma_f32_32x32x16_bf16 v[64:79], v[32:35], v[224:227], v[64:79]
  ds_read_b64_tr_b16 v[60:61], v24 offset:6144
  ds_read_b64_tr_b16 v[62:63], v24 offset:6656
  s_waitcnt lgkmcnt(12)
  v_mfma_f32_32x32x16_bf16 v[64:79], v[36:39], v[228:231], v[64:79]
  s_waitcnt lgkmcnt(10)
  v_mfma_f32_32x32x16_bf16 v[64:79], v[40:43], v[232:235], v[64:79]
  ds_read_b64 v[12:13], v29 offset:3072
  s_waitcnt lgkmcnt(9)
  v_mfma_f32_32x32x16_bf16 v[64:79], v[44:47], v[236:239], v[64:79]
  s_waitcnt lgkmcnt(7)
  v_mfma_f32_32x32x16_bf16 v[64:79], v[48:51], v[240:243], v[64:79]
  s_waitcnt lgkmcnt(5)
  v_mfma_f32_32x32x16_bf16 v[64:79], v[52:55], v[244:247], v[64:79]
  s_waitcnt lgkmcnt(3)
  v_mfma_f32_32x32x16_bf16 v[64:79], v[56:59], v[248:251], v[64:79]
  s_waitcnt lgkmcnt(1)
  v_mfma_f32_32x32x16_bf16 v[64:79], v[60:63], v[252:255], v[64:79]
  s_waitcnt lgkmcnt(0)
  v_mov_b32 v27, 8
  s_mov_b64 exec, 1
  ds_write_b32 v30, v27
  s_mov_b64 exec, -1
  v_mfma_f32_32x32x8bf16_1k v[64:79], v[12:13], v[4:5], v[64:79]
  ds_read_b32 v28, v31
  s_nop 10
  v_pk_mul_f32 v[32:33], v[64:65], v[64:65]
  v_pk_mul_f32 v[34:35], v[66:67], v[66:67]
  v_pk_mul_f32 v[36:37], v[68:69], v[68:69]
  v_pk_mul_f32 v[38:39], v[70:71], v[70:71]
  v_pk_mul_f32 v[40:41], v[72:73], v[72:73]
  v_pk_mul_f32 v[42:43], v[74:75], v[74:75]
  v_pk_mul_f32 v[44:45], v[76:77], v[76:77]
  v_pk_mul_f32 v[46:47], v[78:79], v[78:79]
  v_pk_fma_f32 v[32:33], v[32:33], v[8:9], v[6:7]
  v_pk_fma_f32 v[34:35], v[34:35], v[8:9], v[6:7]
  v_pk_fma_f32 v[36:37], v[36:37], v[8:9], v[6:7]
  v_pk_fma_f32 v[38:39], v[38:39], v[8:9], v[6:7]
  v_pk_fma_f32 v[40:41], v[40:41], v[8:9], v[6:7]
  v_pk_fma_f32 v[42:43], v[42:43], v[8:9], v[6:7]
  v_pk_fma_f32 v[44:45], v[44:45], v[8:9], v[6:7]
  v_pk_fma_f32 v[46:47], v[46:47], v[8:9], v[6:7]
  v_pk_mul_f32 v[32:33], v[32:33], v[64:65]
  v_pk_mul_f32 v[34:35], v[34:35], v[66:67]
  v_pk_mul_f32 v[36:37], v[36:37], v[68:69]
  v_pk_mul_f32 v[38:39], v[38:39], v[70:71]
  v_pk_mul_f32 v[40:41], v[40:41], v[72:73]
  v_pk_mul_f32 v[42:43], v[42:43], v[74:75]
  v_pk_mul_f32 v[44:45], v[44:45], v[76:77]
  v_pk_mul_f32 v[46:47], v[46:47], v[78:79]
  v_exp_f32 v32, v32
  v_exp_f32 v33, v33
  v_exp_f32 v34, v34
  v_exp_f32 v35, v35
  v_exp_f32 v36, v36
  v_exp_f32 v37, v37
  v_exp_f32 v38, v38
  v_exp_f32 v39, v39
  v_exp_f32 v40, v40
  v_exp_f32 v41, v41
  v_exp_f32 v42, v42
  v_exp_f32 v43, v43
  v_exp_f32 v44, v44
  v_exp_f32 v45, v45
  v_exp_f32 v46, v46
  v_exp_f32 v47, v47
  v_pk_fma_f32 v[32:33], v[32:33], v[10:11], v[10:11]
  v_pk_fma_f32 v[34:35], v[34:35], v[10:11], v[10:11]
  v_pk_fma_f32 v[36:37], v[36:37], v[10:11], v[10:11]
  v_pk_fma_f32 v[38:39], v[38:39], v[10:11], v[10:11]
  v_pk_fma_f32 v[40:41], v[40:41], v[10:11], v[10:11]
  v_pk_fma_f32 v[42:43], v[42:43], v[10:11], v[10:11]
  v_pk_fma_f32 v[44:45], v[44:45], v[10:11], v[10:11]
  v_pk_fma_f32 v[46:47], v[46:47], v[10:11], v[10:11]
  v_rcp_f32 v32, v32
  v_rcp_f32 v33, v33
  v_rcp_f32 v34, v34
  v_rcp_f32 v35, v35
  v_rcp_f32 v36, v36
  v_rcp_f32 v37, v37
  v_rcp_f32 v38, v38
  v_rcp_f32 v39, v39
  v_rcp_f32 v40, v40
  v_rcp_f32 v41, v41
  v_rcp_f32 v42, v42
  v_rcp_f32 v43, v43
  v_rcp_f32 v44, v44
  v_rcp_f32 v45, v45
  v_rcp_f32 v46, v46
  v_rcp_f32 v47, v47
  v_pk_mul_f32 v[32:33], v[32:33], v[64:65]
  v_pk_mul_f32 v[34:35], v[34:35], v[66:67]
  v_pk_mul_f32 v[36:37], v[36:37], v[68:69]
  v_pk_mul_f32 v[38:39], v[38:39], v[70:71]
  v_pk_mul_f32 v[40:41], v[40:41], v[72:73]
  v_pk_mul_f32 v[42:43], v[42:43], v[74:75]
  v_pk_mul_f32 v[44:45], v[44:45], v[76:77]
  v_pk_mul_f32 v[46:47], v[46:47], v[78:79]
  v_cvt_pk_bf16_f32 v64, v32, v33
  v_cvt_pk_bf16_f32 v65, v34, v35
  v_cvt_pk_bf16_f32 v66, v36, v37
  v_cvt_pk_bf16_f32 v67, v38, v39
  v_cvt_pk_bf16_f32 v68, v40, v41
  v_cvt_pk_bf16_f32 v69, v42, v43
  v_cvt_pk_bf16_f32 v70, v44, v45
  v_cvt_pk_bf16_f32 v71, v46, v47
  s_waitcnt lgkmcnt(0)
  v_cmp_gt_u32 vcc, 2, v28
  s_nop 1
  s_cbranch_vccz L_w17_x
  s_mov_b32 s71, 1048576
L_w17:
  ds_read_b32 v28, v31
  s_sub_u32 s71, s71, 1
  s_waitcnt lgkmcnt(0)
  v_cmp_gt_u32 vcc, 2, v28
  s_cbranch_scc1 L_w17_x
  s_nop 0
  s_cbranch_vccnz L_w17
L_w17_x:
  ds_write_b128 v26, v[64:67] offset:20480
  ds_write_b128 v26, v[68:71] offset:24576
  s_waitcnt lgkmcnt(0)
  v_mov_b32 v27, 10
  s_mov_b64 exec, 1
  ds_write_b32 v30, v27
  s_mov_b64 exec, -1
  s_branch L_c2
L_p2:
  ds_read_b64_tr_b16 v[32:33], v24 offset:8192
  ds_read_b64_tr_b16 v[34:35], v24 offset:8704
  ds_read_b64_tr_b16 v[36:37], v25 offset:8192
  ds_read_b64_tr_b16 v[38:39], v25 offset:8704
  ds_read_b64_tr_b16 v[40:41], v24 offset:10240
  ds_read_b64_tr_b16 v[42:43], v24 offset:10752
  ds_read_b64_tr_b16 v[44:45], v25 offset:10240
  ds_read_b64_tr_b16 v[46:47], v25 offset:10752
  ds_read_b64_tr_b16 v[48:49], v24 offset:12288
  ds_read_b64_tr_b16 v[50:51], v24 offset:12800
  ds_read_b64_tr_b16 v[52:53], v25 offset:12288
  ds_read_b64_tr_b16 v[54:55], v25 offset:12800
  s_waitcnt lgkmcnt(14)
  ds_read_b64_tr_b16 v[56:57], v24 offset:14336
  s_waitcnt lgkmcnt(14)
  ds_read_b64_tr_b16 v[58:59], v24 offset:14848
  s_waitcnt lgkmcnt(12)
  v_mfma_f32_32x32x16_bf16 v[64:79], v[32:35], v[128:131], 0
  ds_read_b64_tr_b16 v[60:61], v25 offset:14336
  ds_read_b64_tr_b16 v[62:63], v25 offset:14848
  s_waitcnt lgkmcnt(12)
  v_mfma_f32_32x32x16_bf16 v[80:95], v[36:39], v[128:131], 0
  ds_read_b64_tr_b16 v[32:33], v24 offset:16384
  ds_read_b64_tr_b16 v[34:35], v24 offset:16896
  s_waitcnt lgkmcnt(12)
  v_mfma_f32_32x32x16_bf16 v[64:79], v[40:43], v[132:135], v[64:79]
  ds_read_b64_tr_b16 v[36:37], v25 offset:16384
  ds_read_b64_tr_b16 v[38:39], v25 offset:16896
  v_and_b32 v107, 31, v0
  s_waitcnt lgkmcnt(12)
  v_mfma_f32_32x32x16_bf16 v[80:95], v[44:47], v[132:135], v[80:95]
  ds_read_b64_tr_b16 v[40:41], v24 offset:18432
  ds_read_b64_tr_b16 v[42:43], v24 offset:18944
  v_lshlrev_b32 v107, 2, v107
  s_waitcnt lgkmcnt(12)
  v_mfma_f32_32x32x16_bf16 v[64:79], v[48:51], v[136:139], v[64:79]
  ds_read_b64_tr_b16 v[44:45], v25 offset:18432
  ds_read_b64_tr_b16 v[46:47], v25 offset:18944
  v_and_b32 v106, 28, v107
  s_waitcnt lgkmcnt(12)
  v_mfma_f32_32x32x16_bf16 v[80:95], v[52:55], v[136:139], v[80:95]
  ds_read_b64_tr_b16 v[48:49], v24 offset:20480
  ds_read_b64_tr_b16 v[50:51], v24 offset:20992
  v_lshrrev_b32 v113, 5, v0
  s_waitcnt lgkmcnt(12)
  v_mfma_f32_32x32x16_bf16 v[64:79], v[56:59], v[140:143], v[64:79]
  ds_read_b64_tr_b16 v[52:53], v25 offset:20480
  ds_read_b64_tr_b16 v[54:55], v25 offset:20992
  v_bfe_u32 v114, v0, 2, 2
  s_waitcnt lgkmcnt(12)
  v_mfma_f32_32x32x16_bf16 v[80:95], v[60:63], v[140:143], v[80:95]
  ds_read_b64_tr_b16 v[56:57], v24 offset:22528
  ds_read_b64_tr_b16 v[58:59], v24 offset:23040
  v_lshl_add_u32 v113, v113, 2, v114
  s_waitcnt lgkmcnt(12)
  v_mfma_f32_32x32x16_bf16 v[64:79], v[32:35], v[144:147], v[64:79]
  ds_read_b64_tr_b16 v[60:61], v25 offset:22528
  ds_read_b64_tr_b16 v[62:63], v25 offset:23040
  v_lshlrev_b32 v96, 7, v113
  s_waitcnt lgkmcnt(12)
  v_mfma_f32_32x32x16_bf16 v[80:95], v[36:39], v[144:147], v[80:95]
  ds_read_b64_tr_b16 v[32:33], v24 offset:24576
  ds_read_b64_tr_b16 v[34:35], v24 offset:25088
  v_bfe_u32 v113, v0, 3, 1
  s_waitcnt lgkmcnt(12)
  v_mfma_f32_32x32x16_bf16 v[64:79], v[40:43], v[148:151], v[64:79]
  ds_read_b64_tr_b16 v[36:37], v25 offset:24576
  ds_read_b64_tr_b16 v[38:39], v25 offset:25088
  v_lshl_or_b32 v96, v113, 6, v96
  s_waitcnt lgkmcnt(12)
  v_mfma_f32_32x32x16_bf16 v[80:95], v[44:47], v[148:151], v[80:95]
  ds_read_b64_tr_b16 v[40:41], v24 offset:26624
  ds_read_b64_tr_b16 v[42:43], v24 offset:27136
  v_bfe_u32 v113, v0, 4, 1
  s_waitcnt lgkmcnt(12)
  v_mfma_f32_32x32x16_bf16 v[64:79], v[48:51], v[152:155], v[64:79]
  ds_read_b64_tr_b16 v[44:45], v25 offset:26624
  ds_read_b64_tr_b16 v[46:47], v25 offset:27136
  v_lshl_or_b32 v96, v113, 5, v96
  s_waitcnt lgkmcnt(12)
  v_mfma_f32_32x32x16_bf16 v[80:95], v[52:55], v[152:155], v[80:95]
  ds_read_b64_tr_b16 v[48:49], v24 offset:28672
  ds_read_b64_tr_b16 v[50:51], v24 offset:29184
  v_and_b32 v113, 3, v0
  s_waitcnt lgkmcnt(12)
  v_mfma_f32_32x32x16_bf16 v[64:79], v[56:59], v[156:159], v[64:79]
  ds_read_b64_tr_b16 v[52:53], v25 offset:28672
  ds_read_b64_tr_b16 v[54:55], v25 offset:29184
  v_lshl_or_b32 v96, v113, 3, v96
  s_waitcnt lgkmcnt(12)
  v_mfma_f32_32x32x16_bf16 v[80:95], v[60:63], v[156:159], v[80:95]
  ds_read_b64_tr_b16 v[56:57], v24 offset:30720
  ds_read_b64_tr_b16 v[58:59], v24 offset:31232
  v_add_u32 v96, s72, v96
  s_waitcnt lgkmcnt(12)
  v_mfma_f32_32x32x16_bf16 v[64:79], v[32:35], v[160:163], v[64:79]
  ds_read_b64_tr_b16 v[60:61], v25 offset:30720
  ds_read_b64_tr_b16 v[62:63], v25 offset:31232
  v_xor_b32 v97, 64, v96
  s_waitcnt lgkmcnt(12)
  v_mfma_f32_32x32x16_bf16 v[80:95], v[36:39], v[160:163], v[80:95]
  ds_read_b64_tr_b16 v[32:33], v24 offset:32768
  ds_read_b64_tr_b16 v[34:35], v24 offset:33280
  v_add_u32 v98, 0x10000, v96
  s_waitcnt lgkmcnt(12)
  v_mfma_f32_32x32x16_bf16 v[64:79], v[40:43], v[164:167], v[64:79]
  ds_read_b64_tr_b16 v[36:37], v25 offset:32768
  ds_read_b64_tr_b16 v[38:39], v25 offset:33280
  v_add_u32 v99, 0x10000, v97
  s_waitcnt lgkmcnt(12)
  v_mfma_f32_32x32x16_bf16 v[80:95], v[44:47], v[164:167], v[80:95]
  ds_read_b64_tr_b16 v[40:41], v24 offset:34816
  ds_read_b64_tr_b16 v[42:43], v24 offset:35328
  v_add_u32 v100, 0x20000, v96
  s_waitcnt lgkmcnt(12)
  v_mfma_f32_32x32x16_bf16 v[64:79], v[48:51], v[168:171], v[64:79]
  ds_read_b64_tr_b16 v[44:45], v25 offset:34816
  ds_read_b64_tr_b16 v[46:47], v25 offset:35328
  v_add_u32 v101, 0x20000, v97
  s_waitcnt lgkmcnt(12)
  v_mfma_f32_32x32x16_bf16 v[80:95], v[52:55], v[168:171], v[80:95]
  ds_read_b64_tr_b16 v[48:49], v24 offset:36864
  ds_read_b64_tr_b16 v[50:51], v24 offset:37376
  v_lshrrev_b32 v113, 1, s72
  s_waitcnt lgkmcnt(12)
  v_mfma_f32_32x32x16_bf16 v[64:79], v[56:59], v[172:175], v[64:79]
  ds_read_b64_tr_b16 v[52:53], v25 offset:36864
  ds_read_b64_tr_b16 v[54:55], v25 offset:37376
  v_add_u32 v102, v113, v1
  s_waitcnt lgkmcnt(12)
  v_mfma_f32_32x32x16_bf16 v[80:95], v[60:63], v[172:175], v[80:95]
  ds_read_b64_tr_b16 v[56:57], v24 offset:38912
  ds_read_b64_tr_b16 v[58:59], v24 offset:39424
  v_add_u32 v103, 0x1000, v102
  s_waitcnt lgkmcnt(12)
  v_mfma_f32_32x32x16_bf16 v[64:79], v[32:35], v[176:179], v[64:79]
  ds_read_b64_tr_b16 v[60:61], v25 offset:38912
  ds_read_b64_tr_b16 v[62:63], v25 offset:39424
  v_lshrrev_b32 v113, 5, v0
  s_waitcnt lgkmcnt(12)
  v_mfma_f32_32x32x16_bf16 v[80:95], v[36:39], v[176:179], v[80:95]
  ds_read_b64_tr_b16 v[32:33], v24 offset:40960
  ds_read_b64_tr_b16 v[34:35], v24 offset:41472
  v_and_b32 v114, 7, v0
  s_waitcnt lgkmcnt(12)
  v_mfma_f32_32x32x16_bf16 v[64:79], v[40:43], v[180:183], v[64:79]
  ds_read_b64_tr_b16 v[36:37], v25 offset:40960
  ds_read_b64_tr_b16 v[38:39], v25 offset:41472
  v_xor_b32 v113, v113, v114
  s_waitcnt lgkmcnt(12)
  v_mfma_f32_32x32x16_bf16 v[80:95], v[44:47], v[180:183], v[80:95]
  ds_read_b64_tr_b16 v[40:41], v24 offset:43008
  ds_read_b64_tr_b16 v[42:43], v24 offset:43520
  v_lshlrev_b32 v113, 4, v113
  s_waitcnt lgkmcnt(12)
  v_mfma_f32_32x32x16_bf16 v[64:79], v[48:51], v[184:187], v[64:79]
  ds_read_b64_tr_b16 v[44:45], v25 offset:43008
  ds_read_b64_tr_b16 v[46:47], v25 offset:43520
  v_and_b32 v114, 31, v0
  s_waitcnt lgkmcnt(12)
  v_mfma_f32_32x32x16_bf16 v[80:95], v[52:55], v[184:187], v[80:95]
  ds_read_b64_tr_b16 v[48:49], v24 offset:45056
  ds_read_b64_tr_b16 v[50:51], v24 offset:45568
  v_lshl_or_b32 v113, v114, 8, v113
  s_waitcnt lgkmcnt(12)
  v_mfma_f32_32x32x16_bf16 v[64:79], v[56:59], v[188:191], v[64:79]
  ds_read_b64_tr_b16 v[52:53], v25 offset:45056
  ds_read_b64_tr_b16 v[54:55], v25 offset:45568
  v_add_u32 v108, s73, v113
  s_waitcnt lgkmcnt(12)
  v_mfma_f32_32x32x16_bf16 v[80:95], v[60:63], v[188:191], v[80:95]
  ds_read_b64_tr_b16 v[56:57], v24 offset:47104
  ds_read_b64_tr_b16 v[58:59], v24 offset:47616
  v_xor_b32 v109, 32, v108
  s_waitcnt lgkmcnt(12)
  v_mfma_f32_32x32x16_bf16 v[64:79], v[32:35], v[192:195], v[64:79]
  ds_read_b64_tr_b16 v[60:61], v25 offset:47104
  ds_read_b64_tr_b16 v[62:63], v25 offset:47616
  v_xor_b32 v110, 64, v108
  s_waitcnt lgkmcnt(12)
  v_mfma_f32_32x32x16_bf16 v[80:95], v[36:39], v[192:195], v[80:95]
  ds_read_b64_tr_b16 v[32:33], v24 offset:49152
  ds_read_b64_tr_b16 v[34:35], v24 offset:49664
  v_xor_b32 v111, 96, v108
  s_waitcnt lgkmcnt(12)
  v_mfma_f32_32x32x16_bf16 v[64:79], v[40:43], v[196:199], v[64:79]
  ds_read_b64_tr_b16 v[36:37], v25 offset:49152
  ds_read_b64_tr_b16 v[38:39], v25 offset:49664
  v_add_u32 v112, 16, v31
  s_waitcnt lgkmcnt(12)
  v_mfma_f32_32x32x16_bf16 v[80:95], v[44:47], v[196:199], v[80:95]
  ds_read_b64_tr_b16 v[40:41], v24 offset:51200
  ds_read_b64_tr_b16 v[42:43], v24 offset:51712
  v_add_u32 v116, s15, v108
  s_waitcnt lgkmcnt(12)
  v_mfma_f32_32x32x16_bf16 v[64:79], v[48:51], v[200:203], v[64:79]
  ds_read_b64_tr_b16 v[44:45], v25 offset:51200
  ds_read_b64_tr_b16 v[46:47], v25 offset:51712
  v_add_u32 v117, s15, v109
  buffer_load_dword v104, v106, s[16:19], s51 offen sc1
  s_waitcnt lgkmcnt(12)
  v_mfma_f32_32x32x16_bf16 v[80:95], v[52:55], v[200:203], v[80:95]
  ds_read_b64_tr_b16 v[48:49], v24 offset:53248
  ds_read_b64_tr_b16 v[50:51], v24 offset:53760
  v_add_u32 v118, s15, v110
  s_waitcnt lgkmcnt(12)
  v_mfma_f32_32x32x16_bf16 v[64:79], v[56:59], v[204:207], v[64:79]
  ds_read_b64_tr_b16 v[52:53], v25 offset:53248
  ds_read_b64_tr_b16 v[54:55], v25 offset:53760
  v_add_u32 v119, s15, v111
  s_waitcnt lgkmcnt(12)
  v_mfma_f32_32x32x16_bf16 v[80:95], v[60:63], v[204:207], v[80:95]
  ds_read_b64_tr_b16 v[56:57], v24 offset:55296
  ds_read_b64_tr_b16 v[58:59], v24 offset:55808
  s_waitcnt lgkmcnt(12)
  v_mfma_f32_32x32x16_bf16 v[64:79], v[32:35], v[208:211], v[64:79]
  ds_read_b64_tr_b16 v[60:61], v25 offset:55296
  ds_read_b64_tr_b16 v[62:63], v25 offset:55808
  s_waitcnt lgkmcnt(12)
  v_mfma_f32_32x32x16_bf16 v[80:95], v[36:39], v[208:211], v[80:95]
  ds_read_b64_tr_b16 v[32:33], v24 offset:57344
  ds_read_b64_tr_b16 v[34:35], v24 offset:57856
  s_waitcnt lgkmcnt(12)
  v_mfma_f32_32x32x16_bf16 v[64:79], v[40:43], v[212:215], v[64:79]
  ds_read_b64_tr_b16 v[36:37], v25 offset:57344
  ds_read_b64_tr_b16 v[38:39], v25 offset:57856
  s_waitcnt lgkmcnt(12)
  v_mfma_f32_32x32x16_bf16 v[80:95], v[44:47], v[212:215], v[80:95]
  ds_read_b64_tr_b16 v[40:41], v24 offset:59392
  ds_read_b64_tr_b16 v[42:43], v24 offset:59904
  s_waitcnt lgkmcnt(12)
  v_mfma_f32_32x32x16_bf16 v[64:79], v[48:51], v[216:219], v[64:79]
  ds_read_b64_tr_b16 v[44:45], v25 offset:59392
  ds_read_b64_tr_b16 v[46:47], v25 offset:59904
  s_waitcnt lgkmcnt(12)
  v_mfma_f32_32x32x16_bf16 v[80:95], v[52:55], v[216:219], v[80:95]
  ds_read_b64_tr_b16 v[48:49], v24 offset:61440
  ds_read_b64_tr_b16 v[50:51], v24 offset:61952
  s_waitcnt lgkmcnt(12)
  v_mfma_f32_32x32x16_bf16 v[64:79], v[56:59], v[220:223], v[64:79]
  ds_read_b64_tr_b16 v[52:53], v25 offset:61440
  ds_read_b64_tr_b16 v[54:55], v25 offset:61952
  s_waitcnt lgkmcnt(12)
  v_mfma_f32_32x32x16_bf16 v[80:95], v[60:63], v[220:223], v[80:95]
  ds_read_b64_tr_b16 v[56:57], v24 offset:63488
  ds_read_b64_tr_b16 v[58:59], v24 offset:64000
  s_waitcnt lgkmcnt(12)
  v_mfma_f32_32x32x16_bf16 v[64:79], v[32:35], v[224:227], v[64:79]
  ds_read_b64_tr_b16 v[60:61], v25 offset:63488
  ds_read_b64_tr_b16 v[62:63], v25 offset:64000
  s_waitcnt lgkmcnt(12)
  v_mfma_f32_32x32x16_bf16 v[80:95], v[36:39], v[224:227], v[80:95]
  ds_read_b64_tr_b16 v[32:33], v24 offset:0
  ds_read_b64_tr_b16 v[34:35], v24 offset:512
  s_waitcnt lgkmcnt(12)
  v_mfma_f32_32x32x16_bf16 v[64:79], v[40:43], v[228:231], v[64:79]
  ds_read_b64_tr_b16 v[36:37], v25 offset:0
  ds_read_b64_tr_b16 v[38:39], v25 offset:512
  s_waitcnt lgkmcnt(12)
  v_mfma_f32_32x32x16_bf16 v[80:95], v[44:47], v[228:231], v[80:95]
  ds_read_b64_tr_b16 v[40:41], v24 offset:2048
  ds_read_b64_tr_b16 v[42:43], v24 offset:2560
  s_waitcnt lgkmcnt(12)
  v_mfma_f32_32x32x16_bf16 v[64:79], v[48:51], v[232:235], v[64:79]
  ds_read_b64_tr_b16 v[44:45], v25 offset:2048
  ds_read_b64_tr_b16 v[46:47], v25 offset:2560
  s_waitcnt lgkmcnt(12)
  v_mfma_f32_32x32x16_bf16 v[80:95], v[52:55], v[232:235], v[80:95]
  ds_read_b64_tr_b16 v[48:49], v24 offset:4096
  ds_read_b64_tr_b16 v[50:51], v24 offset:4608
  s_waitcnt lgkmcnt(12)
  v_mfma_f32_32x32x16_bf16 v[64:79], v[56:59], v[236:239], v[64:79]
  ds_read_b64_tr_b16 v[52:53], v25 offset:4096
  ds_read_b64_tr_b16 v[54:55], v25 offset:4608
  s_waitcnt lgkmcnt(12)
  v_mfma_f32_32x32x16_bf16 v[80:95], v[60:63], v[236:239], v[80:95]
  ds_read_b64_tr_b16 v[56:57], v24 offset:6144
  ds_read_b64_tr_b16 v[58:59], v24 offset:6656
  s_waitcnt lgkmcnt(12)
  v_mfma_f32_32x32x16_bf16 v[64:79], v[32:35], v[240:243], v[64:79]
  ds_read_b64_tr_b16 v[60:61], v25 offset:6144
  ds_read_b64_tr_b16 v[62:63], v25 offset:6656
  s_waitcnt lgkmcnt(12)
  v_mfma_f32_32x32x16_bf16 v[80:95], v[36:39], v[240:243], v[80:95]
  s_waitcnt lgkmcnt(10)
  v_mfma_f32_32x32x16_bf16 v[64:79], v[40:43], v[244:247], v[64:79]
  ds_read_b64 v[12:13], v29 offset:3072
  ds_read_b64 v[14:15], v29 offset:3584
  s_waitcnt lgkmcnt(10)
  v_mfma_f32_32x32x16_bf16 v[80:95], v[44:47], v[244:247], v[80:95]
  s_waitcnt lgkmcnt(8)
  v_mfma_f32_32x32x16_bf16 v[64:79], v[48:51], v[248:251], v[64:79]
  s_waitcnt lgkmcnt(6)
  v_mfma_f32_32x32x16_bf16 v[80:95], v[52:55], v[248:251], v[80:95]
  s_waitcnt lgkmcnt(4)
  v_mfma_f32_32x32x16_bf16 v[64:79], v[56:59], v[252:255], v[64:79]
  s_waitcnt lgkmcnt(2)
  v_mfma_f32_32x32x16_bf16 v[80:95], v[60:63], v[252:255], v[80:95]
  s_waitcnt lgkmcnt(0)
  v_mov_b32 v27, 8
  s_mov_b64 exec, 1
  ds_write_b32 v30, v27
  s_mov_b64 exec, -1
  v_mfma_f32_32x32x8bf16_1k v[64:79], v[12:13], v[4:5], v[64:79]
  v_mfma_f32_32x32x8bf16_1k v[80:95], v[14:15], v[4:5], v[80:95]
  s_cmp_eq_u32 s63, 0
  s_nop 7
  s_cbranch_scc0 L_cB2
  s_lshl_b32 s68, s59, 12
  s_add_u32 s68, s68, 0x12000
  v_add_u32 v26, s68, v1
  ds_read_b32 v28, v112
  s_nop 4
  v_pk_mul_f32 v[32:33], v[64:65], v[18:19]
  v_pk_mul_f32 v[34:35], v[66:67], v[18:19]
  v_pk_mul_f32 v[36:37], v[68:69], v[18:19]
  v_pk_mul_f32 v[38:39], v[70:71], v[18:19]
  v_pk_mul_f32 v[40:41], v[72:73], v[18:19]
  v_pk_mul_f32 v[42:43], v[74:75], v[18:19]
  v_pk_mul_f32 v[44:45], v[76:77], v[18:19]
  v_pk_mul_f32 v[46:47], v[78:79], v[18:19]
  v_exp_f32 v32, v32
  v_exp_f32 v33, v33
  v_exp_f32 v34, v34
  v_exp_f32 v35, v35
  v_exp_f32 v36, v36
  v_exp_f32 v37, v37
  v_exp_f32 v38, v38
  v_exp_f32 v39, v39
  v_exp_f32 v40, v40
  v_exp_f32 v41, v41
  v_exp_f32 v42, v42
  v_exp_f32 v43, v43
  v_exp_f32 v44, v44
  v_exp_f32 v45, v45
  v_exp_f32 v46, v46
  v_exp_f32 v47, v47
  v_pk_fma_f32 v[64:65], v[64:65], v[16:17], 1.0 op_sel_hi:[1,1,0]
  v_pk_fma_f32 v[66:67], v[66:67], v[16:17], 1.0 op_sel_hi:[1,1,0]
  v_pk_fma_f32 v[68:69], v[68:69], v[16:17], 1.0 op_sel_hi:[1,1,0]
  v_pk_fma_f32 v[70:71], v[70:71], v[16:17], 1.0 op_sel_hi:[1,1,0]
  v_pk_fma_f32 v[72:73], v[72:73], v[16:17], 1.0 op_sel_hi:[1,1,0]
  v_pk_fma_f32 v[74:75], v[74:75], v[16:17], 1.0 op_sel_hi:[1,1,0]
  v_pk_fma_f32 v[76:77], v[76:77], v[16:17], 1.0 op_sel_hi:[1,1,0]
  v_pk_fma_f32 v[78:79], v[78:79], v[16:17], 1.0 op_sel_hi:[1,1,0]
  v_med3_f32 v32, v32, v64, 1.0
  v_med3_f32 v33, v33, v65, 1.0
  v_med3_f32 v34, v34, v66, 1.0
  v_med3_f32 v35, v35, v67, 1.0
  v_med3_f32 v36, v36, v68, 1.0
  v_med3_f32 v37, v37, v69, 1.0
  v_med3_f32 v38, v38, v70, 1.0
  v_med3_f32 v39, v39, v71, 1.0
  v_med3_f32 v40, v40, v72, 1.0
  v_med3_f32 v41, v41, v73, 1.0
  v_med3_f32 v42, v42, v74, 1.0
  v_med3_f32 v43, v43, v75, 1.0
  v_med3_f32 v44, v44, v76, 1.0
  v_med3_f32 v45, v45, v77, 1.0
  v_med3_f32 v46, v46, v78, 1.0
  v_med3_f32 v47, v47, v79, 1.0
  v_pk_add_f32 v[32:33], v[32:33], s[74:75]
  v_pk_add_f32 v[34:35], v[34:35], s[74:75]
  v_pk_add_f32 v[36:37], v[36:37], s[74:75]
  v_pk_add_f32 v[38:39], v[38:39], s[74:75]
  v_pk_add_f32 v[40:41], v[40:41], s[74:75]
  v_pk_add_f32 v[42:43], v[42:43], s[74:75]
  v_pk_add_f32 v[44:45], v[44:45], s[74:75]
  v_pk_add_f32 v[46:47], v[46:47], s[74:75]
  v_cvt_pk_bf16_f32 v48, v32, v33
  v_cvt_pk_bf16_f32 v49, v34, v35
  v_cvt_pk_bf16_f32 v50, v36, v37
  v_cvt_pk_bf16_f32 v51, v38, v39
  v_cvt_pk_bf16_f32 v52, v40, v41
  v_cvt_pk_bf16_f32 v53, v42, v43
  v_cvt_pk_bf16_f32 v54, v44, v45
  v_cvt_pk_bf16_f32 v55, v46, v47
  s_waitcnt lgkmcnt(0)
  v_cmp_gt_u32 vcc, 2, v28
  s_nop 1
  s_cbranch_vccz L_w18_x
  s_mov_b32 s71, 1048576
L_w18:
  ds_read_b32 v28, v112
  s_sub_u32 s71, s71, 1
  s_waitcnt lgkmcnt(0)
  v_cmp_gt_u32 vcc, 2, v28
  s_cbranch_scc1 L_w18_x
  s_nop 0
  s_cbranch_vccnz L_w18
L_w18_x:
  ds_write_b128 v26, v[48:51] offset:0
  ds_write_b128 v26, v[52:55] offset:1024
  v_pk_mul_f32 v[32:33], v[80:81], v[18:19]
  v_pk_mul_f32 v[34:35], v[82:83], v[18:19]
  v_pk_mul_f32 v[36:37], v[84:85], v[18:19]
  v_pk_mul_f32 v[38:39], v[86:87], v[18:19]
  v_pk_mul_f32 v[40:41], v[88:89], v[18:19]
  v_pk_mul_f32 v[42:43], v[90:91], v[18:19]
  v_pk_mul_f32 v[44:45], v[92:93], v[18:19]
  v_pk_mul_f32 v[46:47], v[94:95], v[18:19]
  v_exp_f32 v32, v32
  v_exp_f32 v33, v33
  v_exp_f32 v34, v34
  v_exp_f32 v35, v35
  v_exp_f32 v36, v36
  v_exp_f32 v37, v37
  v_exp_f32 v38, v38
  v_exp_f32 v39, v39
  v_exp_f32 v40, v40
  v_exp_f32 v41, v41
  v_exp_f32 v42, v42
  v_exp_f32 v43, v43
  v_exp_f32 v44, v44
  v_exp_f32 v45, v45
  v_exp_f32 v46, v46
  v_exp_f32 v47, v47
  v_pk_fma_f32 v[80:81], v[80:81], v[16:17], 1.0 op_sel_hi:[1,1,0]
  v_pk_fma_f32 v[82:83], v[82:83], v[16:17], 1.0 op_sel_hi:[1,1,0]
  v_pk_fma_f32 v[84:85], v[84:85], v[16:17], 1.0 op_sel_hi:[1,1,0]
  v_pk_fma_f32 v[86:87], v[86:87], v[16:17], 1.0 op_sel_hi:[1,1,0]
  v_pk_fma_f32 v[88:89], v[88:89], v[16:17], 1.0 op_sel_hi:[1,1,0]
  v_pk_fma_f32 v[90:91], v[90:91], v[16:17], 1.0 op_sel_hi:[1,1,0]
  v_pk_fma_f32 v[92:93], v[92:93], v[16:17], 1.0 op_sel_hi:[1,1,0]
  v_pk_fma_f32 v[94:95], v[94:95], v[16:17], 1.0 op_sel_hi:[1,1,0]
  v_med3_f32 v32, v32, v80, 1.0
  v_med3_f32 v33, v33, v81, 1.0
  v_med3_f32 v34, v34, v82, 1.0
  v_med3_f32 v35, v35, v83, 1.0
  v_med3_f32 v36, v36, v84, 1.0
  v_med3_f32 v37, v37, v85, 1.0
  v_med3_f32 v38, v38, v86, 1.0
  v_med3_f32 v39, v39, v87, 1.0
  v_med3_f32 v40, v40, v88, 1.0
  v_med3_f32 v41, v41, v89, 1.0
  v_med3_f32 v42, v42, v90, 1.0
  v_med3_f32 v43, v43, v91, 1.0
  v_med3_f32 v44, v44, v92, 1.0
  v_med3_f32 v45, v45, v93, 1.0
  v_med3_f32 v46, v46, v94, 1.0
  v_med3_f32 v47, v47, v95, 1.0
  v_pk_add_f32 v[32:33], v[32:33], s[74:75]
  v_pk_add_f32 v[34:35], v[34:35], s[74:75]
  v_pk_add_f32 v[36:37], v[36:37], s[74:75]
  v_pk_add_f32 v[38:39], v[38:39], s[74:75]
  v_pk_add_f32 v[40:41], v[40:41], s[74:75]
  v_pk_add_f32 v[42:43], v[42:43], s[74:75]
  v_pk_add_f32 v[44:45], v[44:45], s[74:75]
  v_pk_add_f32 v[46:47], v[46:47], s[74:75]
  v_cvt_pk_bf16_f32 v56, v32, v33
  v_cvt_pk_bf16_f32 v57, v34, v35
  v_cvt_pk_bf16_f32 v58, v36, v37
  v_cvt_pk_bf16_f32 v59, v38, v39
  v_cvt_pk_bf16_f32 v60, v40, v41
  v_cvt_pk_bf16_f32 v61, v42, v43
  v_cvt_pk_bf16_f32 v62, v44, v45
  v_cvt_pk_bf16_f32 v63, v46, v47
  ds_write_b128 v26, v[56:59] offset:2048
  ds_write_b128 v26, v[60:63] offset:3072
  s_waitcnt lgkmcnt(0)
  v_mov_b32 v27, 10
  s_mov_b64 exec, 1
  ds_write_b32 v30, v27
  s_mov_b64 exec, -1
  s_branch L_c2
L_cB2:
  ds_read_b32 v28, v31
  v_pk_mul_f32 v[32:33], v[64:65], v[64:65]
  v_pk_mul_f32 v[34:35], v[66:67], v[66:67]
  v_pk_mul_f32 v[36:37], v[68:69], v[68:69]
  v_pk_mul_f32 v[38:39], v[70:71], v[70:71]
  v_pk_mul_f32 v[40:41], v[72:73], v[72:73]
  v_pk_mul_f32 v[42:43], v[74:75], v[74:75]
  v_pk_mul_f32 v[44:45], v[76:77], v[76:77]
  v_pk_mul_f32 v[46:47], v[78:79], v[78:79]
  v_pk_fma_f32 v[32:33], v[32:33], v[8:9], v[6:7]
  v_pk_fma_f32 v[34:35], v[34:35], v[8:9], v[6:7]
  v_pk_fma_f32 v[36:37], v[36:37], v[8:9], v[6:7]
  v_pk_fma_f32 v[38:39], v[38:39], v[8:9], v[6:7]
  v_pk_fma_f32 v[40:41], v[40:41], v[8:9], v[6:7]
  v_pk_fma_f32 v[42:43], v[42:43], v[8:9], v[6:7]
  v_pk_fma_f32 v[44:45], v[44:45], v[8:9], v[6:7]
  v_pk_fma_f32 v[46:47], v[46:47], v[8:9], v[6:7]
  v_pk_mul_f32 v[32:33], v[32:33], v[64:65]
  v_pk_mul_f32 v[34:35], v[34:35], v[66:67]
  v_pk_mul_f32 v[36:37], v[36:37], v[68:69]
  v_pk_mul_f32 v[38:39], v[38:39], v[70:71]
  v_pk_mul_f32 v[40:41], v[40:41], v[72:73]
  v_pk_mul_f32 v[42:43], v[42:43], v[74:75]
  v_pk_mul_f32 v[44:45], v[44:45], v[76:77]
  v_pk_mul_f32 v[46:47], v[46:47], v[78:79]
  v_exp_f32 v32, v32
  v_exp_f32 v33, v33
  v_exp_f32 v34, v34
  v_exp_f32 v35, v35
  v_exp_f32 v36, v36
  v_exp_f32 v37, v37
  v_exp_f32 v38, v38
  v_exp_f32 v39, v39
  v_exp_f32 v40, v40
  v_exp_f32 v41, v41
  v_exp_f32 v42, v42
  v_exp_f32 v43, v43
  v_exp_f32 v44, v44
  v_exp_f32 v45, v45
  v_exp_f32 v46, v46
  v_exp_f32 v47, v47
  v_pk_fma_f32 v[32:33], v[32:33], v[10:11], v[10:11]
  v_pk_fma_f32 v[34:35], v[34:35], v[10:11], v[10:11]
  v_pk_fma_f32 v[36:37], v[36:37], v[10:11], v[10:11]
  v_pk_fma_f32 v[38:39], v[38:39], v[10:11], v[10:11]
  v_pk_fma_f32 v[40:41], v[40:41], v[10:11], v[10:11]
  v_pk_fma_f32 v[42:43], v[42:43], v[10:11], v[10:11]
  v_pk_fma_f32 v[44:45], v[44:45], v[10:11], v[10:11]
  v_pk_fma_f32 v[46:47], v[46:47], v[10:11], v[10:11]
  v_rcp_f32 v32, v32
  v_rcp_f32 v33, v33
  v_rcp_f32 v34, v34
  v_rcp_f32 v35, v35
  v_rcp_f32 v36, v36
  v_rcp_f32 v37, v37
  v_rcp_f32 v38, v38
  v_rcp_f32 v39, v39
  v_rcp_f32 v40, v40
  v_rcp_f32 v41, v41
  v_rcp_f32 v42, v42
  v_rcp_f32 v43, v43
  v_rcp_f32 v44, v44
  v_rcp_f32 v45, v45
  v_rcp_f32 v46, v46
  v_rcp_f32 v47, v47
  v_pk_mul_f32 v[32:33], v[32:33], v[64:65]
  v_pk_mul_f32 v[34:35], v[34:35], v[66:67]
  v_pk_mul_f32 v[36:37], v[36:37], v[68:69]
  v_pk_mul_f32 v[38:39], v[38:39], v[70:71]
  v_pk_mul_f32 v[40:41], v[40:41], v[72:73]
  v_pk_mul_f32 v[42:43], v[42:43], v[74:75]
  v_pk_mul_f32 v[44:45], v[44:45], v[76:77]
  v_pk_mul_f32 v[46:47], v[46:47], v[78:79]
  v_cvt_pk_bf16_f32 v64, v32, v33
  v_cvt_pk_bf16_f32 v65, v34, v35
  v_cvt_pk_bf16_f32 v66, v36, v37
  v_cvt_pk_bf16_f32 v67, v38, v39
  v_cvt_pk_bf16_f32 v68, v40, v41
  v_cvt_pk_bf16_f32 v69, v42, v43
  v_cvt_pk_bf16_f32 v70, v44, v45
  v_cvt_pk_bf16_f32 v71, v46, v47
  s_waitcnt lgkmcnt(0)
  v_cmp_gt_u32 vcc, 2, v28
  s_nop 1
  s_cbranch_vccz L_w19_x
  s_mov_b32 s71, 1048576
L_w19:
  ds_read_b32 v28, v31
  s_sub_u32 s71, s71, 1
  s_waitcnt lgkmcnt(0)
  v_cmp_gt_u32 vcc, 2, v28
  s_cbranch_scc1 L_w19_x
  s_nop 0
  s_cbranch_vccnz L_w19
L_w19_x:
  ds_write_b128 v26, v[64:67] offset:20480
  ds_write_b128 v26, v[68:71] offset:24576
  v_pk_mul_f32 v[32:33], v[80:81], v[80:81]
  v_pk_mul_f32 v[34:35], v[82:83], v[82:83]
  v_pk_mul_f32 v[36:37], v[84:85], v[84:85]
  v_pk_mul_f32 v[38:39], v[86:87], v[86:87]
  v_pk_mul_f32 v[40:41], v[88:89], v[88:89]
  v_pk_mul_f32 v[42:43], v[90:91], v[90:91]
  v_pk_mul_f32 v[44:45], v[92:93], v[92:93]
  v_pk_mul_f32 v[46:47], v[94:95], v[94:95]
  v_pk_fma_f32 v[32:33], v[32:33], v[8:9], v[6:7]
  v_pk_fma_f32 v[34:35], v[34:35], v[8:9], v[6:7]
  v_pk_fma_f32 v[36:37], v[36:37], v[8:9], v[6:7]
  v_pk_fma_f32 v[38:39], v[38:39], v[8:9], v[6:7]
  v_pk_fma_f32 v[40:41], v[40:41], v[8:9], v[6:7]
  v_pk_fma_f32 v[42:43], v[42:43], v[8:9], v[6:7]
  v_pk_fma_f32 v[44:45], v[44:45], v[8:9], v[6:7]
  v_pk_fma_f32 v[46:47], v[46:47], v[8:9], v[6:7]
  v_pk_mul_f32 v[32:33], v[32:33], v[80:81]
  v_pk_mul_f32 v[34:35], v[34:35], v[82:83]
  v_pk_mul_f32 v[36:37], v[36:37], v[84:85]
  v_pk_mul_f32 v[38:39], v[38:39], v[86:87]
  v_pk_mul_f32 v[40:41], v[40:41], v[88:89]
  v_pk_mul_f32 v[42:43], v[42:43], v[90:91]
  v_pk_mul_f32 v[44:45], v[44:45], v[92:93]
  v_pk_mul_f32 v[46:47], v[46:47], v[94:95]
  s_waitcnt lgkmcnt(0)
  v_mov_b32 v27, 9
  s_mov_b64 exec, 1
  ds_write_b32 v30, v27
  s_mov_b64 exec, -1
  v_exp_f32 v32, v32
  v_exp_f32 v33, v33
  v_exp_f32 v34, v34
  v_exp_f32 v35, v35
  v_exp_f32 v36, v36
  v_exp_f32 v37, v37
  v_exp_f32 v38, v38
  v_exp_f32 v39, v39
  v_exp_f32 v40, v40
  v_exp_f32 v41, v41
  v_exp_f32 v42, v42
  v_exp_f32 v43, v43
  v_exp_f32 v44, v44
  v_exp_f32 v45, v45
  v_exp_f32 v46, v46
  v_exp_f32 v47, v47
  v_pk_fma_f32 v[32:33], v[32:33], v[10:11], v[10:11]
  v_pk_fma_f32 v[34:35], v[34:35], v[10:11], v[10:11]
  v_pk_fma_f32 v[36:37], v[36:37], v[10:11], v[10:11]
  v_pk_fma_f32 v[38:39], v[38:39], v[10:11], v[10:11]
  v_pk_fma_f32 v[40:41], v[40:41], v[10:11], v[10:11]
  v_pk_fma_f32 v[42:43], v[42:43], v[10:11], v[10:11]
  v_pk_fma_f32 v[44:45], v[44:45], v[10:11], v[10:11]
  v_pk_fma_f32 v[46:47], v[46:47], v[10:11], v[10:11]
  v_rcp_f32 v32, v32
  v_rcp_f32 v33, v33
  v_rcp_f32 v34, v34
  v_rcp_f32 v35, v35
  v_rcp_f32 v36, v36
  v_rcp_f32 v37, v37
  v_rcp_f32 v38, v38
  v_rcp_f32 v39, v39
  v_rcp_f32 v40, v40
  v_rcp_f32 v41, v41
  v_rcp_f32 v42, v42
  v_rcp_f32 v43, v43
  v_rcp_f32 v44, v44
  v_rcp_f32 v45, v45
  v_rcp_f32 v46, v46
  v_rcp_f32 v47, v47
  v_pk_mul_f32 v[32:33], v[32:33], v[80:81]
  v_pk_mul_f32 v[34:35], v[34:35], v[82:83]
  v_pk_mul_f32 v[36:37], v[36:37], v[84:85]
  v_pk_mul_f32 v[38:39], v[38:39], v[86:87]
  v_pk_mul_f32 v[40:41], v[40:41], v[88:89]
  v_pk_mul_f32 v[42:43], v[42:43], v[90:91]
  v_pk_mul_f32 v[44:45], v[44:45], v[92:93]
  v_pk_mul_f32 v[46:47], v[46:47], v[94:95]
  v_cvt_pk_bf16_f32 v80, v32, v33
  v_cvt_pk_bf16_f32 v81, v34, v35
  v_cvt_pk_bf16_f32 v82, v36, v37
  v_cvt_pk_bf16_f32 v83, v38, v39
  v_cvt_pk_bf16_f32 v84, v40, v41
  v_cvt_pk_bf16_f32 v85, v42, v43
  v_cvt_pk_bf16_f32 v86, v44, v45
  v_cvt_pk_bf16_f32 v87, v46, v47
  ds_write_b128 v26, v[80:83] offset:28672
  ds_write_b128 v26, v[84:87] offset:32768
  s_waitcnt lgkmcnt(0)
  v_mov_b32 v27, 10
  s_mov_b64 exec, 1
  ds_write_b32 v30, v27
  s_mov_b64 exec, -1
L_c2:
  s_cmp_lg_u32 s55, 0
  s_cbranch_scc1 L_primed
  s_waitcnt vmcnt(0)
  v_cmp_ne_u32 vcc, s58, v104
  s_nop 1
  s_cbranch_vccz L_hb_x
  s_mov_b32 s71, 65536
L_hb:
  buffer_load_dword v104, v106, s[16:19], s51 offen sc1
  s_waitcnt vmcnt(0)
  v_cmp_ne_u32 vcc, s58, v104
  s_sub_u32 s71, s71, 1
  s_cbranch_scc1 L_hb_x
  s_cbranch_vccz L_hb_x
  s_sleep 2
  s_branch L_hb
L_hb_x:
  buffer_load_dwordx4 v[128:131], v102, s[16:19], s36 offen offset:0 sc1
  buffer_load_dwordx4 v[132:135], v102, s[16:19], s36 offen offset:1024 sc1
  buffer_load_dwordx4 v[136:139], v102, s[16:19], s37 offen offset:0 sc1
  buffer_load_dwordx4 v[140:143], v102, s[16:19], s37 offen offset:1024 sc1
  buffer_load_dwordx4 v[144:147], v102, s[16:19], s38 offen offset:0 sc1
  buffer_load_dwordx4 v[148:151], v102, s[16:19], s38 offen offset:1024 sc1
  buffer_load_dwordx4 v[152:155], v102, s[16:19], s39 offen offset:0 sc1
  buffer_load_dwordx4 v[156:159], v102, s[16:19], s39 offen offset:1024 sc1
L_primed:
  ds_read_b32 v20, v31
  s_waitcnt lgkmcnt(0)
  v_cmp_gt_u32 vcc, 3, v20
  s_nop 1
  s_cbranch_vccz L_w20_x
  s_mov_b32 s71, 1048576
L_w20:
  ds_read_b32 v20, v31
  s_sub_u32 s71, s71, 1
  s_waitcnt lgkmcnt(0)
  v_cmp_gt_u32 vcc, 3, v20
  s_cbranch_scc1 L_w20_x
  s_nop 0
  s_cbranch_vccnz L_w20
L_w20_x:
  ds_read_b64_tr_b16 v[32:33], v96 offset:0
  ds_read_b64_tr_b16 v[34:35], v96 offset:1024
  ds_read_b64_tr_b16 v[36:37], v97 offset:0
  ds_read_b64_tr_b16 v[38:39], v97 offset:1024
  ds_read_b64_tr_b16 v[40:41], v96 offset:2048
  ds_read_b64_tr_b16 v[42:43], v96 offset:3072
  ds_read_b64_tr_b16 v[44:45], v97 offset:2048
  ds_read_b64_tr_b16 v[46:47], v97 offset:3072
  ds_read_b64_tr_b16 v[48:49], v96 offset:8192
  ds_read_b64_tr_b16 v[50:51], v96 offset:9216
  ds_read_b64_tr_b16 v[52:53], v97 offset:8192
  ds_read_b64_tr_b16 v[54:55], v97 offset:9216
  ds_read_b64_tr_b16 v[56:57], v96 offset:10240
  ds_read_b64_tr_b16 v[58:59], v96 offset:11264
  s_waitcnt vmcnt(7) lgkmcnt(10)
  v_mfma_f32_32x32x16_bf16 v[64:79], v[32:35], v[128:131], 0
  ds_read_b64_tr_b16 v[60:61], v97 offset:10240
  ds_read_b64_tr_b16 v[62:63], v97 offset:11264
  v_mfma_f32_32x32x16_bf16 v[80:95], v[36:39], v[128:131], 0
  buffer_load_dword v104, v106, s[16:19], s44 offen sc1
  buffer_load_dwordx4 v[128:131], v102, s[16:19], s40 offen offset:0 sc1
  ds_read_b64_tr_b16 v[32:33], v96 offset:16384
  ds_read_b64_tr_b16 v[34:35], v96 offset:17408
  s_waitcnt vmcnt(8) lgkmcnt(10)
  v_mfma_f32_32x32x16_bf16 v[64:79], v[40:43], v[132:135], v[64:79]
  ds_read_b64_tr_b16 v[36:37], v97 offset:16384
  ds_read_b64_tr_b16 v[38:39], v97 offset:17408
  v_mfma_f32_32x32x16_bf16 v[80:95], v[44:47], v[132:135], v[80:95]
  buffer_load_dwordx4 v[132:135], v102, s[16:19], s40 offen offset:1024 sc1
  ds_read_b64_tr_b16 v[40:41], v96 offset:18432
  ds_read_b64_tr_b16 v[42:43], v96 offset:19456
  s_waitcnt vmcnt(8) lgkmcnt(10)
  v_mfma_f32_32x32x16_bf16 v[64:79], v[48:51], v[136:139], v[64:79]
  ds_read_b64_tr_b16 v[44:45], v97 offset:18432
  ds_read_b64_tr_b16 v[46:47], v97 offset:19456
  v_mfma_f32_32x32x16_bf16 v[80:95], v[52:55], v[136:139], v[80:95]
  buffer_load_dwordx4 v[136:139], v102, s[16:19], s41 offen offset:0 sc1
  ds_read_b64_tr_b16 v[48:49], v96 offset:24576
  ds_read_b64_tr_b16 v[50:51], v96 offset:25600
  s_waitcnt vmcnt(8) lgkmcnt(10)
  v_mfma_f32_32x32x16_bf16 v[64:79], v[56:59], v[140:143], v[64:79]
  ds_read_b64_tr_b16 v[52:53], v97 offset:24576
  ds_read_b64_tr_b16 v[54:55], v97 offset:25600
  v_mfma_f32_32x32x16_bf16 v[80:95], v[60:63], v[140:143], v[80:95]
  buffer_load_dwordx4 v[140:143], v102, s[16:19], s41 offen offset:1024 sc1
  ds_read_b64_tr_b16 v[56:57], v96 offset:26624
  ds_read_b64_tr_b16 v[58:59], v96 offset:27648
  s_waitcnt vmcnt(8) lgkmcnt(10)
  v_mfma_f32_32x32x16_bf16 v[64:79], v[32:35], v[144:147], v[64:79]
  ds_read_b64_tr_b16 v[60:61], v97 offset:26624
  ds_read_b64_tr_b16 v[62:63], v97 offset:27648
  v_mfma_f32_32x32x16_bf16 v[80:95], v[36:39], v[144:147], v[80:95]
  buffer_load_dwordx4 v[144:147], v102, s[16:19], s42 offen offset:0 sc1
  ds_read_b64_tr_b16 v[32:33], v96 offset:32768
  ds_read_b64_tr_b16 v[34:35], v96 offset:33792
  s_waitcnt vmcnt(8) lgkmcnt(10)
  v_mfma_f32_32x32x16_bf16 v[64:79], v[40:43], v[148:151], v[64:79]
  ds_read_b64_tr_b16 v[36:37], v97 offset:32768
  ds_read_b64_tr_b16 v[38:39], v97 offset:33792
  v_mfma_f32_32x32x16_bf16 v[80:95], v[44:47], v[148:151], v[80:95]
  buffer_load_dwordx4 v[148:151], v102, s[16:19], s42 offen offset:1024 sc1
  ds_read_b64_tr_b16 v[40:41], v96 offset:34816
  ds_read_b64_tr_b16 v[42:43], v96 offset:35840
  s_waitcnt vmcnt(8) lgkmcnt(10)
  v_mfma_f32_32x32x16_bf16 v[64:79], v[48:51], v[152:155], v[64:79]
  ds_read_b64_tr_b16 v[44:45], v97 offset:34816
  ds_read_b64_tr_b16 v[46:47], v97 offset:35840
  v_mfma_f32_32x32x16_bf16 v[80:95], v[52:55], v[152:155], v[80:95]
  buffer_load_dwordx4 v[152:155], v102, s[16:19], s43 offen offset:0 sc1
  ds_read_b64_tr_b16 v[48:49], v96 offset:40960
  ds_read_b64_tr_b16 v[50:51], v96 offset:41984
  s_waitcnt vmcnt(8) lgkmcnt(10)
  v_mfma_f32_32x32x16_bf16 v[64:79], v[56:59], v[156:159], v[64:79]
  ds_read_b64_tr_b16 v[52:53], v97 offset:40960
  ds_read_b64_tr_b16 v[54:55], v97 offset:41984
  v_mfma_f32_32x32x16_bf16 v[80:95], v[60:63], v[156:159], v[80:95]
  buffer_load_dwordx4 v[156:159], v102, s[16:19], s43 offen offset:1024 sc1
  ds_read_b64_tr_b16 v[56:57], v96 offset:43008
  ds_read_b64_tr_b16 v[58:59], v96 offset:44032
  s_waitcnt vmcnt(7) lgkmcnt(10)
  v_mfma_f32_32x32x16_bf16 v[64:79], v[32:35], v[128:131], v[64:79]
  ds_read_b64_tr_b16 v[60:61], v97 offset:43008
  ds_read_b64_tr_b16 v[62:63], v97 offset:44032
  v_mfma_f32_32x32x16_bf16 v[80:95], v[36:39], v[128:131], v[80:95]
  v_cmp_ne_u32 vcc, s58, v104
  s_nop 1
  s_cbranch_vccz L_h1_x
  s_mov_b32 s71, 65536
L_h1:
  buffer_load_dword v104, v106, s[16:19], s44 offen sc1
  s_waitcnt vmcnt(0)
  v_cmp_ne_u32 vcc, s58, v104
  s_sub_u32 s71, s71, 1
  s_cbranch_scc1 L_h1_x
  s_cbranch_vccz L_h1_x
  s_sleep 2
  s_branch L_h1
L_h1_x:
  buffer_load_dwordx4 v[128:131], v103, s[16:19], s36 offen offset:0 sc1
  ds_read_b64_tr_b16 v[32:33], v96 offset:49152
  ds_read_b64_tr_b16 v[34:35], v96 offset:50176
  s_waitcnt vmcnt(7) lgkmcnt(10)
  v_mfma_f32_32x32x16_bf16 v[64:79], v[40:43], v[132:135], v[64:79]
  ds_read_b64_tr_b16 v[36:37], v97 offset:49152
  ds_read_b64_tr_b16 v[38:39], v97 offset:50176
  v_mfma_f32_32x32x16_bf16 v[80:95], v[44:47], v[132:135], v[80:95]
  buffer_load_dwordx4 v[132:135], v103, s[16:19], s36 offen offset:1024 sc1
  ds_read_b64_tr_b16 v[40:41], v96 offset:51200
  ds_read_b64_tr_b16 v[42:43], v96 offset:52224
  s_waitcnt vmcnt(7) lgkmcnt(10)
  v_mfma_f32_32x32x16_bf16 v[64:79], v[48:51], v[136:139], v[64:79]
  ds_read_b64_tr_b16 v[44:45], v97 offset:51200
  ds_read_b64_tr_b16 v[46:47], v97 offset:52224
  v_mfma_f32_32x32x16_bf16 v[80:95], v[52:55], v[136:139], v[80:95]
  buffer_load_dwordx4 v[136:139], v103, s[16:19], s37 offen offset:0 sc1
  ds_read_b64_tr_b16 v[48:49], v96 offset:57344
  ds_read_b64_tr_b16 v[50:51], v96 offset:58368
  s_waitcnt vmcnt(7) lgkmcnt(10)
  v_mfma_f32_32x32x16_bf16 v[64:79], v[56:59], v[140:143], v[64:79]
  ds_read_b64_tr_b16 v[52:53], v97 offset:57344
  ds_read_b64_tr_b16 v[54:55], v97 offset:58368
  v_mfma_f32_32x32x16_bf16 v[80:95], v[60:63], v[140:143], v[80:95]
  buffer_load_dwordx4 v[140:143], v103, s[16:19], s37 offen offset:1024 sc1
  ds_read_b64_tr_b16 v[56:57], v96 offset:59392
  ds_read_b64_tr_b16 v[58:59], v96 offset:60416
  s_waitcnt vmcnt(7) lgkmcnt(10)
  v_mfma_f32_32x32x16_bf16 v[64:79], v[32:35], v[144:147], v[64:79]
  ds_read_b32 v20, v31
  ds_read_b64_tr_b16 v[60:61], v97 offset:59392
  ds_read_b64_tr_b16 v[62:63], v97 offset:60416
  v_mfma_f32_32x32x16_bf16 v[80:95], v[36:39], v[144:147], v[80:95]
  buffer_load_dwordx4 v[144:147], v103, s[16:19], s38 offen offset:0 sc1
  ds_read_b64_tr_b16 v[32:33], v98 offset:0
  ds_read_b64_tr_b16 v[34:35], v98 offset:1024
  s_waitcnt vmcnt(7) lgkmcnt(11)
  v_mfma_f32_32x32x16_bf16 v[64:79], v[40:43], v[148:151], v[64:79]
  ds_read_b64_tr_b16 v[36:37], v99 offset:0
  ds_read_b64_tr_b16 v[38:39], v99 offset:1024
  v_mfma_f32_32x32x16_bf16 v[80:95], v[44:47], v[148:151], v[80:95]
  buffer_load_dwordx4 v[148:151], v103, s[16:19], s38 offen offset:1024 sc1
  ds_read_b64_tr_b16 v[40:41], v98 offset:2048
  ds_read_b64_tr_b16 v[42:43], v98 offset:3072
  s_waitcnt vmcnt(7) lgkmcnt(11)
  v_mfma_f32_32x32x16_bf16 v[64:79], v[48:51], v[152:155], v[64:79]
  ds_read_b64_tr_b16 v[44:45], v99 offset:2048
  ds_read_b64_tr_b16 v[46:47], v99 offset:3072
  v_mfma_f32_32x32x16_bf16 v[80:95], v[52:55], v[152:155], v[80:95]
  buffer_load_dwordx4 v[152:155], v103, s[16:19], s39 offen offset:0 sc1
  v_mov_b32 v21, 11
  s_mov_b64 exec, 1
  ds_write_b32 v30, v21
  s_mov_b64 exec, -1
  s_waitcnt lgkmcnt(11)
  v_cmp_gt_u32 vcc, 4, v20
  s_nop 1
  s_cbranch_vccz L_w21_x
  s_mov_b32 s71, 1048576
L_w21:
  ds_read_b32 v20, v31
  s_sub_u32 s71, s71, 1
  s_waitcnt lgkmcnt(0)
  v_cmp_gt_u32 vcc, 4, v20
  s_cbranch_scc1 L_w21_x
  s_nop 0
  s_cbranch_vccnz L_w21
L_w21_x:
  ds_read_b64_tr_b16 v[48:49], v98 offset:32768
  ds_read_b64_tr_b16 v[50:51], v98 offset:33792
  s_waitcnt vmcnt(7) lgkmcnt(11)
  v_mfma_f32_32x32x16_bf16 v[64:79], v[56:59], v[156:159], v[64:79]
  ds_read_b64_tr_b16 v[52:53], v99 offset:32768
  ds_read_b64_tr_b16 v[54:55], v99 offset:33792
  v_mfma_f32_32x32x16_bf16 v[80:95], v[60:63], v[156:159], v[80:95]
  buffer_load_dwordx4 v[156:159], v103, s[16:19], s39 offen offset:1024 sc1
  ds_read_b64_tr_b16 v[56:57], v98 offset:34816
  ds_read_b64_tr_b16 v[58:59], v98 offset:35840
  s_waitcnt vmcnt(7) lgkmcnt(11)
  v_mfma_f32_32x32x16_bf16 v[64:79], v[32:35], v[128:131], v[64:79]
  ds_read_b64_tr_b16 v[60:61], v99 offset:34816
  ds_read_b64_tr_b16 v[62:63], v99 offset:35840
  v_mfma_f32_32x32x16_bf16 v[80:95], v[36:39], v[128:131], v[80:95]
  buffer_load_dword v104, v106, s[16:19], s54 offen sc1
  buffer_load_dwordx4 v[128:131], v103, s[16:19], s40 offen offset:0 sc1
  ds_read_b64_tr_b16 v[32:33], v98 offset:40960
  ds_read_b64_tr_b16 v[34:35], v98 offset:41984
  s_waitcnt vmcnt(8) lgkmcnt(11)
  v_mfma_f32_32x32x16_bf16 v[64:79], v[40:43], v[132:135], v[64:79]
  ds_read_b64_tr_b16 v[36:37], v99 offset:40960
  ds_read_b64_tr_b16 v[38:39], v99 offset:41984
  v_mfma_f32_32x32x16_bf16 v[80:95], v[44:47], v[132:135], v[80:95]
  buffer_load_dwordx4 v[132:135], v103, s[16:19], s40 offen offset:1024 sc1
  ds_read_b64_tr_b16 v[40:41], v98 offset:43008
  ds_read_b64_tr_b16 v[42:43], v98 offset:44032
  s_waitcnt vmcnt(8) lgkmcnt(10)
  v_mfma_f32_32x32x16_bf16 v[64:79], v[48:51], v[136:139], v[64:79]
  ds_read_b64_tr_b16 v[44:45], v99 offset:43008
  ds_read_b64_tr_b16 v[46:47], v99 offset:44032
  v_mfma_f32_32x32x16_bf16 v[80:95], v[52:55], v[136:139], v[80:95]
  buffer_load_dwordx4 v[136:139], v103, s[16:19], s41 offen offset:0 sc1
  ds_read_b64_tr_b16 v[48:49], v98 offset:49152
  ds_read_b64_tr_b16 v[50:51], v98 offset:50176
  s_waitcnt vmcnt(8) lgkmcnt(10)
  v_mfma_f32_32x32x16_bf16 v[64:79], v[56:59], v[140:143], v[64:79]
  ds_read_b64_tr_b16 v[52:53], v99 offset:49152
  ds_read_b64_tr_b16 v[54:55], v99 offset:50176
  v_mfma_f32_32x32x16_bf16 v[80:95], v[60:63], v[140:143], v[80:95]
  buffer_load_dwordx4 v[140:143], v103, s[16:19], s41 offen offset:1024 sc1
  ds_read_b64_tr_b16 v[56:57], v98 offset:51200
  ds_read_b64_tr_b16 v[58:59], v98 offset:52224
  s_waitcnt vmcnt(8) lgkmcnt(10)
  v_mfma_f32_32x32x16_bf16 v[64:79], v[32:35], v[144:147], v[64:79]
  ds_read_b64_tr_b16 v[60:61], v99 offset:51200
  ds_read_b64_tr_b16 v[62:63], v99 offset:52224
  v_mfma_f32_32x32x16_bf16 v[80:95], v[36:39], v[144:147], v[80:95]
  buffer_load_dwordx4 v[144:147], v103, s[16:19], s42 offen offset:0 sc1
  ds_read_b64_tr_b16 v[32:33], v98 offset:57344
  ds_read_b64_tr_b16 v[34:35], v98 offset:58368
  s_waitcnt vmcnt(8) lgkmcnt(10)
  v_mfma_f32_32x32x16_bf16 v[64:79], v[40:43], v[148:151], v[64:79]
  ds_read_b64_tr_b16 v[36:37], v99 offset:57344
  ds_read_b64_tr_b16 v[38:39], v99 offset:58368
  v_mfma_f32_32x32x16_bf16 v[80:95], v[44:47], v[148:151], v[80:95]
  buffer_load_dwordx4 v[148:151], v103, s[16:19], s42 offen offset:1024 sc1
  ds_read_b64_tr_b16 v[40:41], v98 offset:59392
  ds_read_b64_tr_b16 v[42:43], v98 offset:60416
  s_waitcnt vmcnt(8) lgkmcnt(10)
  v_mfma_f32_32x32x16_bf16 v[64:79], v[48:51], v[152:155], v[64:79]
  ds_read_b64_tr_b16 v[44:45], v99 offset:59392
  ds_read_b64_tr_b16 v[46:47], v99 offset:60416
  v_mfma_f32_32x32x16_bf16 v[80:95], v[52:55], v[152:155], v[80:95]
  buffer_load_dwordx4 v[152:155], v103, s[16:19], s43 offen offset:0 sc1
  v_mov_b32 v21, 12
  s_mov_b64 exec, 1
  ds_write_b32 v30, v21
  s_mov_b64 exec, -1
  ds_read_b64_tr_b16 v[48:49], v100 offset:0
  ds_read_b64_tr_b16 v[50:51], v100 offset:1024
  s_waitcnt vmcnt(8) lgkmcnt(11)
  v_mfma_f32_32x32x16_bf16 v[64:79], v[56:59], v[156:159], v[64:79]
  ds_read_b64_tr_b16 v[52:53], v101 offset:0
  ds_read_b64_tr_b16 v[54:55], v101 offset:1024
  v_mfma_f32_32x32x16_bf16 v[80:95], v[60:63], v[156:159], v[80:95]
  buffer_load_dwordx4 v[156:159], v103, s[16:19], s43 offen offset:1024 sc1
  ds_read_b64_tr_b16 v[56:57], v100 offset:2048
  ds_read_b64_tr_b16 v[58:59], v100 offset:3072
  s_waitcnt vmcnt(7) lgkmcnt(11)
  v_mfma_f32_32x32x16_bf16 v[64:79], v[32:35], v[128:131], v[64:79]
  ds_read_b64_tr_b16 v[60:61], v101 offset:2048
  ds_read_b64_tr_b16 v[62:63], v101 offset:3072
  v_mfma_f32_32x32x16_bf16 v[80:95], v[36:39], v[128:131], v[80:95]
  v_cmp_ne_u32 vcc, s58, v104
  s_nop 1
  s_cbranch_vccz L_ha_x
  s_mov_b32 s71, 65536
L_ha:
  buffer_load_dword v104, v106, s[16:19], s54 offen sc1
  s_waitcnt vmcnt(0)
  v_cmp_ne_u32 vcc, s58, v104
  s_sub_u32 s71, s71, 1
  s_cbranch_scc1 L_ha_x
  s_cbranch_vccz L_ha_x
  s_sleep 2
  s_branch L_ha
L_ha_x:
  buffer_load_dwordx4 v[128:131], v102, s[16:19], s8 offen offset:0 sc1
  ds_read_b64_tr_b16 v[32:33], v100 offset:8192
  ds_read_b64_tr_b16 v[34:35], v100 offset:9216
  s_waitcnt vmcnt(7) lgkmcnt(11)
  v_mfma_f32_32x32x16_bf16 v[64:79], v[40:43], v[132:135], v[64:79]
  ds_read_b64_tr_b16 v[36:37], v101 offset:8192
  ds_read_b64_tr_b16 v[38:39], v101 offset:9216
  v_mfma_f32_32x32x16_bf16 v[80:95], v[44:47], v[132:135], v[80:95]
  buffer_load_dwordx4 v[132:135], v102, s[16:19], s8 offen offset:1024 sc1
  ds_read_b64_tr_b16 v[40:41], v100 offset:10240
  ds_read_b64_tr_b16 v[42:43], v100 offset:11264
  s_waitcnt vmcnt(7) lgkmcnt(10)
  v_mfma_f32_32x32x16_bf16 v[64:79], v[48:51], v[136:139], v[64:79]
  ds_read_b64_tr_b16 v[44:45], v101 offset:10240
  ds_read_b64_tr_b16 v[46:47], v101 offset:11264
  v_mfma_f32_32x32x16_bf16 v[80:95], v[52:55], v[136:139], v[80:95]
  buffer_load_dwordx4 v[136:139], v103, s[16:19], s9 offen offset:0 sc1
  ds_read_b64_tr_b16 v[48:49], v100 offset:16384
  ds_read_b64_tr_b16 v[50:51], v100 offset:17408
  s_waitcnt vmcnt(7) lgkmcnt(10)
  v_mfma_f32_32x32x16_bf16 v[64:79], v[56:59], v[140:143], v[64:79]
  ds_read_b64_tr_b16 v[52:53], v101 offset:16384
  ds_read_b64_tr_b16 v[54:55], v101 offset:17408
  v_mfma_f32_32x32x16_bf16 v[80:95], v[60:63], v[140:143], v[80:95]
  buffer_load_dwordx4 v[140:143], v103, s[16:19], s9 offen offset:1024 sc1
  ds_read_b64_tr_b16 v[56:57], v100 offset:18432
  ds_read_b64_tr_b16 v[58:59], v100 offset:19456
  s_waitcnt vmcnt(7) lgkmcnt(10)
  v_mfma_f32_32x32x16_bf16 v[64:79], v[32:35], v[144:147], v[64:79]
  ds_read_b64_tr_b16 v[60:61], v101 offset:18432
  ds_read_b64_tr_b16 v[62:63], v101 offset:19456
  v_mfma_f32_32x32x16_bf16 v[80:95], v[36:39], v[144:147], v[80:95]
  buffer_load_dword v105, v107, s[16:19], s52 offen sc1
  buffer_load_dwordx4 v[144:147], v102, s[16:19], s10 offen offset:0 sc1
  ds_read_b64_tr_b16 v[32:33], v98 offset:24576
  ds_read_b64_tr_b16 v[34:35], v98 offset:25600
  s_waitcnt vmcnt(8) lgkmcnt(10)
  v_mfma_f32_32x32x16_bf16 v[64:79], v[40:43], v[148:151], v[64:79]
  ds_read_b64_tr_b16 v[36:37], v99 offset:24576
  ds_read_b64_tr_b16 v[38:39], v99 offset:25600
  v_mfma_f32_32x32x16_bf16 v[80:95], v[44:47], v[148:151], v[80:95]
  buffer_load_dwordx4 v[148:151], v102, s[16:19], s10 offen offset:1024 sc1
  ds_read_b64_tr_b16 v[40:41], v98 offset:26624
  ds_read_b64_tr_b16 v[42:43], v98 offset:27648
  s_waitcnt vmcnt(8) lgkmcnt(10)
  v_mfma_f32_32x32x16_bf16 v[64:79], v[48:51], v[152:155], v[64:79]
  ds_read_b64_tr_b16 v[44:45], v99 offset:26624
  ds_read_b64_tr_b16 v[46:47], v99 offset:27648
  v_mfma_f32_32x32x16_bf16 v[80:95], v[52:55], v[152:155], v[80:95]
  buffer_load_dwordx4 v[152:155], v103, s[16:19], s11 offen offset:0 sc1
  ds_read_b64_tr_b16 v[48:49], v98 offset:8192
  ds_read_b64_tr_b16 v[50:51], v98 offset:9216
  s_waitcnt vmcnt(8) lgkmcnt(10)
  v_mfma_f32_32x32x16_bf16 v[64:79], v[56:59], v[156:159], v[64:79]
  ds_read_b64_tr_b16 v[52:53], v99 offset:8192
  ds_read_b64_tr_b16 v[54:55], v99 offset:9216
  v_mfma_f32_32x32x16_bf16 v[80:95], v[60:63], v[156:159], v[80:95]
  buffer_load_dwordx4 v[156:159], v103, s[16:19], s11 offen offset:1024 sc1
  ds_read_b64_tr_b16 v[56:57], v98 offset:10240
  ds_read_b64_tr_b16 v[58:59], v98 offset:11264
  s_waitcnt vmcnt(8) lgkmcnt(10)
  v_mfma_f32_32x32x16_bf16 v[64:79], v[32:35], v[128:131], v[64:79]
  ds_read_b32 v20, v31
  ds_read_b64_tr_b16 v[60:61], v99 offset:10240
  ds_read_b64_tr_b16 v[62:63], v99 offset:11264
  v_mfma_f32_32x32x16_bf16 v[80:95], v[36:39], v[128:131], v[80:95]
  buffer_load_dwordx4 v[128:131], v102, s[16:19], s12 offen offset:0 sc1
  v_mov_b32 v21, 13
  s_mov_b64 exec, 1
  ds_write_b32 v30, v21
  s_mov_b64 exec, -1
  ds_read_b64_tr_b16 v[32:33], v98 offset:16384
  s_waitcnt lgkmcnt(14)
  ds_read_b64_tr_b16 v[34:35], v98 offset:17408
  s_waitcnt vmcnt(8) lgkmcnt(12)
  v_mfma_f32_32x32x16_bf16 v[64:79], v[40:43], v[132:135], v[64:79]
  ds_read_b64_tr_b16 v[36:37], v99 offset:16384
  ds_read_b64_tr_b16 v[38:39], v99 offset:17408
  v_mfma_f32_32x32x16_bf16 v[80:95], v[44:47], v[132:135], v[80:95]
  buffer_load_dwordx4 v[132:135], v102, s[16:19], s12 offen offset:1024 sc1
  ds_read_b64_tr_b16 v[40:41], v98 offset:18432
  s_waitcnt lgkmcnt(14)
  ds_read_b64_tr_b16 v[42:43], v98 offset:19456
  s_waitcnt vmcnt(8) lgkmcnt(12)
  v_mfma_f32_32x32x16_bf16 v[64:79], v[48:51], v[136:139], v[64:79]
  ds_read_b64_tr_b16 v[44:45], v99 offset:18432
  ds_read_b64_tr_b16 v[46:47], v99 offset:19456
  v_mfma_f32_32x32x16_bf16 v[80:95], v[52:55], v[136:139], v[80:95]
  buffer_load_dwordx4 v[136:139], v103, s[16:19], s13 offen offset:0 sc1
  s_waitcnt lgkmcnt(11)
  v_cmp_gt_u32 vcc, 5, v20
  s_nop 1
  s_cbranch_vccz L_w22_x
  s_mov_b32 s71, 1048576
L_w22:
  ds_read_b32 v20, v31
  s_sub_u32 s71, s71, 1
  s_waitcnt lgkmcnt(0)
  v_cmp_gt_u32 vcc, 5, v20
  s_cbranch_scc1 L_w22_x
  s_nop 0
  s_cbranch_vccnz L_w22
L_w22_x:
  ds_read_b64_tr_b16 v[48:49], v96 offset:0
  ds_read_b64_tr_b16 v[50:51], v96 offset:1024
  s_waitcnt vmcnt(8) lgkmcnt(11)
  v_mfma_f32_32x32x16_bf16 v[64:79], v[56:59], v[140:143], v[64:79]
  ds_read_b64_tr_b16 v[52:53], v97 offset:0
  ds_read_b64_tr_b16 v[54:55], v97 offset:1024
  v_mfma_f32_32x32x16_bf16 v[80:95], v[60:63], v[140:143], v[80:95]
  buffer_load_dwordx4 v[140:143], v103, s[16:19], s13 offen offset:1024 sc1
  ds_read_b64_tr_b16 v[56:57], v96 offset:2048
  ds_read_b64_tr_b16 v[58:59], v96 offset:3072
  s_waitcnt vmcnt(7) lgkmcnt(10)
  v_mfma_f32_32x32x16_bf16 v[64:79], v[32:35], v[144:147], v[64:79]
  ds_read_b64_tr_b16 v[60:61], v97 offset:2048
  ds_read_b64_tr_b16 v[62:63], v97 offset:3072
  v_mfma_f32_32x32x16_bf16 v[80:95], v[36:39], v[144:147], v[80:95]
  v_cmp_ne_u32 vcc, s58, v105
  s_nop 1
  s_cbranch_vccz L_o_x
  s_mov_b32 s71, 65536
L_o:
  buffer_load_dword v105, v107, s[16:19], s52 offen sc1
  s_waitcnt vmcnt(0)
  v_cmp_ne_u32 vcc, s58, v105
  s_sub_u32 s71, s71, 1
  s_cbranch_scc1 L_o_x
  s_cbranch_vccz L_o_x
  s_sleep 2
  s_branch L_o
L_o_x:
  buffer_load_dwordx4 v[144:147], v102, s[16:19], s47 offen offset:0 sc1
  ds_read_b64_tr_b16 v[32:33], v96 offset:8192
  ds_read_b64_tr_b16 v[34:35], v96 offset:9216
  s_waitcnt vmcnt(7) lgkmcnt(10)
  v_mfma_f32_32x32x16_bf16 v[64:79], v[40:43], v[148:151], v[64:79]
  ds_read_b64_tr_b16 v[36:37], v97 offset:8192
  ds_read_b64_tr_b16 v[38:39], v97 offset:9216
  v_mfma_f32_32x32x16_bf16 v[80:95], v[44:47], v[148:151], v[80:95]
  buffer_load_dwordx4 v[148:151], v102, s[16:19], s47 offen offset:1024 sc1
  ds_read_b64_tr_b16 v[40:41], v96 offset:10240
  ds_read_b64_tr_b16 v[42:43], v96 offset:11264
  s_waitcnt vmcnt(7) lgkmcnt(10)
  v_mfma_f32_32x32x16_bf16 v[64:79], v[48:51], v[152:155], v[64:79]
  ds_read_b32 v20, v31
  ds_read_b64_tr_b16 v[44:45], v97 offset:10240
  ds_read_b64_tr_b16 v[46:47], v97 offset:11264
  v_mfma_f32_32x32x16_bf16 v[80:95], v[52:55], v[152:155], v[80:95]
  buffer_load_dwordx4 v[152:155], v103, s[16:19], s47 offen offset:0 sc1
  ds_read_b64_tr_b16 v[48:49], v96 offset:16384
  ds_read_b64_tr_b16 v[50:51], v96 offset:17408
  s_waitcnt vmcnt(7) lgkmcnt(11)
  v_mfma_f32_32x32x16_bf16 v[64:79], v[56:59], v[156:159], v[64:79]
  ds_read_b64_tr_b16 v[52:53], v97 offset:16384
  ds_read_b64_tr_b16 v[54:55], v97 offset:17408
  v_mfma_f32_32x32x16_bf16 v[80:95], v[60:63], v[156:159], v[80:95]
  buffer_load_dwordx4 v[156:159], v103, s[16:19], s47 offen offset:1024 sc1
  ds_read_b64_tr_b16 v[56:57], v96 offset:18432
  ds_read_b64_tr_b16 v[58:59], v96 offset:19456
  s_waitcnt vmcnt(7) lgkmcnt(11)
  v_mfma_f32_32x32x16_bf16 v[64:79], v[32:35], v[128:131], v[64:79]
  ds_read_b64_tr_b16 v[60:61], v97 offset:18432
  ds_read_b64_tr_b16 v[62:63], v97 offset:19456
  v_mfma_f32_32x32x16_bf16 v[80:95], v[36:39], v[128:131], v[80:95]
  buffer_load_dwordx4 v[128:131], v102, s[16:19], s48 offen offset:0 sc1
  s_waitcnt lgkmcnt(10)
  v_cmp_gt_u32 vcc, 6, v20
  s_nop 1
  s_cbranch_vccz L_w23_x
  s_mov_b32 s71, 1048576
L_w23:
  ds_read_b32 v20, v31
  s_sub_u32 s71, s71, 1
  s_waitcnt lgkmcnt(0)
  v_cmp_gt_u32 vcc, 6, v20
  s_cbranch_scc1 L_w23_x
  s_nop 0
  s_cbranch_vccnz L_w23
L_w23_x:
  ds_read_b64_tr_b16 v[32:33], v96 offset:24576
  ds_read_b64_tr_b16 v[34:35], v96 offset:25600
  s_waitcnt vmcnt(7) lgkmcnt(10)
  v_mfma_f32_32x32x16_bf16 v[64:79], v[40:43], v[132:135], v[64:79]
  ds_read_b64_tr_b16 v[36:37], v97 offset:24576
  ds_read_b64_tr_b16 v[38:39], v97 offset:25600
  v_mfma_f32_32x32x16_bf16 v[80:95], v[44:47], v[132:135], v[80:95]
  buffer_load_dwordx4 v[132:135], v102, s[16:19], s48 offen offset:1024 sc1
  ds_read_b64_tr_b16 v[40:41], v96 offset:26624
  ds_read_b64_tr_b16 v[42:43], v96 offset:27648
  s_cmp_eq_u32 s53, 0
  s_waitcnt vmcnt(7) lgkmcnt(10)
  s_cbranch_scc0 L_null0
  v_mfma_f32_32x32x16_bf16 v[64:79], v[48:51], v[136:139], v[64:79]
L_null0:
  ds_read_b64_tr_b16 v[44:45], v97 offset:26624
  ds_read_b64_tr_b16 v[46:47], v97 offset:27648
  s_cbranch_scc0 L_null1
  v_mfma_f32_32x32x16_bf16 v[80:95], v[52:55], v[136:139], v[80:95]
L_null1:
  buffer_load_dwordx4 v[136:139], v103, s[16:19], s48 offen offset:0 sc1
  ds_read_b64_tr_b16 v[48:49], v96 offset:32768
  ds_read_b64_tr_b16 v[50:51], v96 offset:33792
  s_waitcnt vmcnt(7) lgkmcnt(10)
  s_cbranch_scc0 L_null2
  v_mfma_f32_32x32x16_bf16 v[64:79], v[56:59], v[140:143], v[64:79]
L_null2:
  ds_read_b32 v19, v112
  ds_read_b64_tr_b16 v[52:53], v97 offset:32768
  ds_read_b64_tr_b16 v[54:55], v97 offset:33792
  s_cbranch_scc0 L_null3
  v_mfma_f32_32x32x16_bf16 v[80:95], v[60:63], v[140:143], v[80:95]
L_null3:
  buffer_load_dwordx4 v[140:143], v103, s[16:19], s48 offen offset:1024 sc1
  ds_read_b64_tr_b16 v[56:57], v96 offset:34816
  ds_read_b64_tr_b16 v[58:59], v96 offset:35840
  s_waitcnt vmcnt(7) lgkmcnt(11)
  v_mfma_f32_32x32x16_bf16 v[192:207], v[32:35], v[144:147], 0
  ds_read_b64_tr_b16 v[60:61], v97 offset:34816
  ds_read_b64_tr_b16 v[62:63], v97 offset:35840
  v_mfma_f32_32x32x16_bf16 v[208:223], v[36:39], v[144:147], 0
  buffer_load_dwordx4 v[144:147], v102, s[16:19], s49 offen offset:0 sc1
  ds_read_b64_tr_b16 v[32:33], v96 offset:40960
  ds_read_b64_tr_b16 v[34:35], v96 offset:41984
  s_waitcnt vmcnt(7) lgkmcnt(11)
  v_mfma_f32_32x32x16_bf16 v[192:207], v[40:43], v[148:151], v[192:207]
  ds_read_b64_tr_b16 v[36:37], v97 offset:40960
  ds_read_b64_tr_b16 v[38:39], v97 offset:41984
  v_mfma_f32_32x32x16_bf16 v[208:223], v[44:47], v[148:151], v[208:223]
  buffer_load_dwordx4 v[148:151], v102, s[16:19], s49 offen offset:1024 sc1
  ds_read_b64_tr_b16 v[40:41], v96 offset:43008
  ds_read_b64_tr_b16 v[42:43], v96 offset:44032
  s_waitcnt lgkmcnt(12)
  v_cmp_gt_u32 vcc, 13, v19
  s_nop 1
  s_cbranch_vccz L_w24_x
  s_mov_b32 s71, 1048576
L_w24:
  ds_read_b32 v19, v112
  s_sub_u32 s71, s71, 1
  s_waitcnt lgkmcnt(0)
  v_cmp_gt_u32 vcc, 13, v19
  s_cbranch_scc1 L_w24_x
  s_nop 0
  s_cbranch_vccnz L_w24
L_w24_x:
  ds_write_b128 v108, v[64:67] offset:0
  s_waitcnt vmcnt(7) lgkmcnt(11)
  v_mfma_f32_32x32x16_bf16 v[192:207], v[48:51], v[152:155], v[192:207]
  ds_read_b64_tr_b16 v[44:45], v97 offset:43008
  ds_read_b64_tr_b16 v[46:47], v97 offset:44032
  ds_write_b128 v109, v[68:71] offset:0
  v_mfma_f32_32x32x16_bf16 v[208:223], v[52:55], v[152:155], v[208:223]
  buffer_load_dwordx4 v[152:155], v103, s[16:19], s49 offen offset:0 sc1
  ds_read_b64_tr_b16 v[48:49], v96 offset:49152
  s_waitcnt lgkmcnt(14)
  ds_read_b64_tr_b16 v[50:51], v96 offset:50176
  s_waitcnt lgkmcnt(14)
  ds_write_b128 v110, v[72:75] offset:0
  s_waitcnt vmcnt(7) lgkmcnt(13)
  v_mfma_f32_32x32x16_bf16 v[192:207], v[56:59], v[156:159], v[192:207]
  ds_read_b64_tr_b16 v[52:53], v97 offset:49152
  ds_read_b64_tr_b16 v[54:55], v97 offset:50176
  s_waitcnt lgkmcnt(14)
  ds_write_b128 v111, v[76:79] offset:0
  v_mfma_f32_32x32x16_bf16 v[208:223], v[60:63], v[156:159], v[208:223]
  buffer_load_dwordx4 v[156:159], v103, s[16:19], s49 offen offset:1024 sc1
  s_waitcnt lgkmcnt(14)
  ds_read_b64_tr_b16 v[56:57], v96 offset:51200
  s_waitcnt lgkmcnt(14)
  ds_read_b64_tr_b16 v[58:59], v96 offset:52224
  s_waitcnt lgkmcnt(14)
  ds_write_b128 v108, v[80:83] offset:128
  s_waitcnt vmcnt(7)
  v_mfma_f32_32x32x16_bf16 v[192:207], v[32:35], v[128:131], v[192:207]
  s_waitcnt lgkmcnt(14)
  ds_read_b64_tr_b16 v[60:61], v97 offset:51200
  s_waitcnt lgkmcnt(14)
  ds_read_b64_tr_b16 v[62:63], v97 offset:52224
  s_waitcnt lgkmcnt(14)
  ds_write_b128 v109, v[84:87] offset:128
  v_mfma_f32_32x32x16_bf16 v[208:223], v[36:39], v[128:131], v[208:223]
  buffer_load_dwordx4 v[128:131], v102, s[16:19], s50 offen offset:0 sc1
  s_waitcnt lgkmcnt(14)
  ds_read_b64_tr_b16 v[32:33], v96 offset:57344
  s_waitcnt lgkmcnt(14)
  ds_read_b64_tr_b16 v[34:35], v96 offset:58368
  s_waitcnt lgkmcnt(14)
  ds_write_b128 v110, v[88:91] offset:128
  s_waitcnt vmcnt(7)
  v_mfma_f32_32x32x16_bf16 v[192:207], v[40:43], v[132:135], v[192:207]
  s_waitcnt lgkmcnt(14)
  ds_read_b64_tr_b16 v[36:37], v97 offset:57344
  s_waitcnt lgkmcnt(14)
  ds_read_b64_tr_b16 v[38:39], v97 offset:58368
  s_waitcnt lgkmcnt(14)
  ds_write_b128 v111, v[92:95] offset:128
  v_mfma_f32_32x32x16_bf16 v[208:223], v[44:47], v[132:135], v[208:223]
  buffer_load_dwordx4 v[132:135], v102, s[16:19], s50 offen offset:1024 sc1
  s_waitcnt lgkmcnt(14)
  ds_read_b64_tr_b16 v[40:41], v96 offset:59392
  s_waitcnt lgkmcnt(14)
  ds_read_b64_tr_b16 v[42:43], v96 offset:60416
  s_waitcnt vmcnt(7)
  v_mfma_f32_32x32x16_bf16 v[192:207], v[48:51], v[136:139], v[192:207]
  s_waitcnt lgkmcnt(14)
  ds_read_b64_tr_b16 v[44:45], v97 offset:59392
  s_waitcnt lgkmcnt(14)
  ds_read_b64_tr_b16 v[46:47], v97 offset:60416
  s_waitcnt lgkmcnt(4)
  s_barrier
  v_mfma_f32_32x32x16_bf16 v[208:223], v[52:55], v[136:139], v[208:223]
  buffer_load_dwordx4 v[136:139], v103, s[16:19], s50 offen offset:0 sc1
  ds_read_b64_tr_b16 v[48:49], v98 offset:0
  ds_read_b64_tr_b16 v[50:51], v98 offset:1024
  s_waitcnt vmcnt(7)
  v_mfma_f32_32x32x16_bf16 v[192:207], v[56:59], v[140:143], v[192:207]
  ds_read_b64_tr_b16 v[52:53], v99 offset:0
  ds_read_b64_tr_b16 v[54:55], v99 offset:1024
  v_mfma_f32_32x32x16_bf16 v[208:223], v[60:63], v[140:143], v[208:223]
  buffer_load_dwordx4 v[140:143], v103, s[16:19], s50 offen offset:1024 sc1
  ds_read_b64_tr_b16 v[56:57], v98 offset:2048
  ds_read_b64_tr_b16 v[58:59], v98 offset:3072
  s_waitcnt vmcnt(7)
  v_mfma_f32_32x32x16_bf16 v[192:207], v[32:35], v[144:147], v[192:207]
  ds_read_b64_tr_b16 v[60:61], v99 offset:2048
  ds_read_b64_tr_b16 v[62:63], v99 offset:3072
  v_mfma_f32_32x32x16_bf16 v[208:223], v[36:39], v[144:147], v[208:223]
  ds_read_b64_tr_b16 v[32:33], v98 offset:32768
  ds_read_b64_tr_b16 v[34:35], v98 offset:33792
  s_waitcnt vmcnt(6) lgkmcnt(10)
  v_mfma_f32_32x32x16_bf16 v[192:207], v[40:43], v[148:151], v[192:207]
  ds_read_b64_tr_b16 v[36:37], v98 offset:34816
  ds_read_b64_tr_b16 v[38:39], v98 offset:35840
  v_mfma_f32_32x32x16_bf16 v[208:223], v[44:47], v[148:151], v[208:223]
  ds_read_b64_tr_b16 v[40:41], v98 offset:40960
  ds_read_b64_tr_b16 v[42:43], v98 offset:41984
  s_waitcnt vmcnt(5) lgkmcnt(10)
  v_mfma_f32_32x32x16_bf16 v[192:207], v[48:51], v[152:155], v[192:207]
  ds_read_b64_tr_b16 v[44:45], v98 offset:43008
  ds_read_b64_tr_b16 v[46:47], v98 offset:44032
  v_mfma_f32_32x32x16_bf16 v[208:223], v[52:55], v[152:155], v[208:223]
  ds_read_b64_tr_b16 v[48:49], v99 offset:32768
  ds_read_b64_tr_b16 v[50:51], v99 offset:33792
  s_waitcnt vmcnt(4) lgkmcnt(10)
  v_mfma_f32_32x32x16_bf16 v[192:207], v[56:59], v[156:159], v[192:207]
  ds_read_b64_tr_b16 v[52:53], v99 offset:34816
  ds_read_b64_tr_b16 v[54:55], v99 offset:35840
  v_mfma_f32_32x32x16_bf16 v[208:223], v[60:63], v[156:159], v[208:223]
  ds_read_b64_tr_b16 v[56:57], v99 offset:40960
  ds_read_b64_tr_b16 v[58:59], v99 offset:41984
  s_waitcnt vmcnt(3) lgkmcnt(10)
  v_mfma_f32_32x32x16_bf16 v[192:207], v[32:35], v[128:131], v[192:207]
  ds_read_b64_tr_b16 v[60:61], v99 offset:43008
  ds_read_b64_tr_b16 v[62:63], v99 offset:44032
  s_waitcnt vmcnt(2)
  v_mfma_f32_32x32x16_bf16 v[192:207], v[36:39], v[132:135], v[192:207]
  s_waitcnt vmcnt(1) lgkmcnt(8)
  v_mfma_f32_32x32x16_bf16 v[192:207], v[40:43], v[136:139], v[192:207]
  s_waitcnt vmcnt(0)
  v_mfma_f32_32x32x16_bf16 v[192:207], v[44:47], v[140:143], v[192:207]
  s_waitcnt lgkmcnt(4)
  v_mfma_f32_32x32x16_bf16 v[208:223], v[48:51], v[128:131], v[208:223]
  v_mfma_f32_32x32x16_bf16 v[208:223], v[52:55], v[132:135], v[208:223]
  s_waitcnt lgkmcnt(0)
  v_mfma_f32_32x32x16_bf16 v[208:223], v[56:59], v[136:139], v[208:223]
  s_nop 6
  ds_write_b128 v116, v[192:195] offset:0
  ds_write_b128 v117, v[196:199] offset:0
  v_mfma_f32_32x32x16_bf16 v[208:223], v[60:63], v[140:143], v[208:223]
  ds_write_b128 v118, v[200:203] offset:0
  ds_write_b128 v119, v[204:207] offset:0
  s_nop 9
  ds_write_b128 v116, v[208:211] offset:128
  ds_write_b128 v117, v[212:215] offset:128
  ds_write_b128 v118, v[216:219] offset:128
  ds_write_b128 v119, v[220:223] offset:128
  s_setprio 0
  s_waitcnt lgkmcnt(0)
  s_barrier
  s_or_b32 s68, s2, s59
  s_cmp_eq_u32 s68, 0
  s_cbranch_scc0 L_cend
  v_mov_b32 v26, s58
  v_mov_b32 v27, 0
  s_mov_b64 exec, 1
  buffer_store_dword v26, v27, s[16:19], s68 offen sc1
  s_mov_b64 exec, -1
L_cend:
  s_endpgm
L_codeend:
.section .rodata,"a"
.p2align 6
.amdhsa_kernel recurrent_scan__linear_attn_block__dense_activation_gelu__prompt_kernel
  .amdhsa_next_free_vgpr 256
  .amdhsa_next_free_sgpr 102
  .amdhsa_accum_offset 256
  .amdhsa_group_segment_fixed_size 0
  .amdhsa_kernarg_size 88
  .amdhsa_user_sgpr_count 2
  .amdhsa_user_sgpr_kernarg_segment_ptr 1
  .amdhsa_system_sgpr_workgroup_id_x 1
  .amdhsa_float_denorm_mode_32 3
.end_amdhsa_kernel
```
